```python
import torch

def _softmax(x, axis=-1):
    return torch.softmax(x, dim=axis)
def _gelu(x):
    return torch.nn.functional.gelu(x, approximate="tanh")
def _silu(x):
    return torch.nn.functional.silu(x)
def _sigmoid(x):
    return torch.sigmoid(x)
def _layernorm(x, axis=-1, eps=1e-5):
    m = x.mean(dim=axis, keepdim=True)
    v = x.var(dim=axis, keepdim=True, unbiased=False)
    return (x - m) / torch.sqrt(v + eps)
def _scatter_add(tgt, idx, src, axis=0):
    return tgt.clone().index_add_(axis, idx, src)
def _segment_sum(src, seg, n):
    out = torch.zeros((n,) + src.shape[1:], dtype=src.dtype)
    return out.index_add_(0, seg, src)
def _pad(x, pw):
    flat = tuple(v for pair in reversed(pw) for v in pair)
    return torch.nn.functional.pad(x, flat)

kernel_name = 'recurrent_scan__spectral_gfnet__dense_activation_relu__prompt'

def setup_inputs():

    _w = (lambda a: (lambda t: t.to(torch.bfloat16) if t.is_floating_point() else t)(torch.as_tensor(a)))
    def _A_setup():
        B, S, D = 1, 2048, 448
        Df = D // 2 + 1
        return {
            "x": _w((lambda *s: torch.randn(*s, dtype=torch.bfloat16) * 0.05)(B, S, D)),
            "w_r": _w((lambda *s: torch.randn(*s, dtype=torch.bfloat16) * 0.1)(S, Df) * 0.02),
            "w_i": _w((lambda *s: torch.randn(*s, dtype=torch.bfloat16) * 0.1)(S, Df) * 0.02),
        }
    _A_in = _A_setup()

    def _B_setup():
        B, S, D, Dff = 1, 2048, 448, 1792
        return {
            "x": _w((lambda *s: torch.randn(*s, dtype=torch.bfloat16) * 0.05)(B, S, D)),
            "w1": _w((lambda *s: torch.randn(*s, dtype=torch.bfloat16) * 0.05)(D, Dff)),
            "w2": _w((lambda *s: torch.randn(*s, dtype=torch.bfloat16) * 0.05)(Dff, D)),
        }
    _B_in = _B_setup()

    return {
        "A_x": _A_in["x"],
        "A_w_r": _A_in["w_r"],
        "A_w_i": _A_in["w_i"],
        "B_x": _B_in["x"],
        "B_w1": _B_in["w1"],
        "B_w2": _B_in["w2"],
    }

def reference(A_x, A_w_r, A_w_i, B_x, B_w1, B_w2):
    def _A_ref(x, w_r, w_i):
        B, S, D = x.shape
        X = (lambda x, axes=(-2,-1): torch.fft.rfft2(x.float(), dim=axes))(x, axes=(-2, -1))
        W = w_r + 1j * w_i
        X = X * W
        y = (lambda x, s, axes=(-2,-1): torch.fft.irfft2(x, s=s, dim=axes).to(torch.bfloat16))(X, (S, D), axes=(-2, -1))
        return y

    def _B_ref(x, w1, w2):
        h = torch.einsum("bsd,df->bsf", x, w1)
        zero = torch.zeros_like(h)
        h = torch.maximum(h, zero)
        return torch.einsum("bsf,fd->bsd", h, w2)

    x = A_x
    xn = _layernorm(x, axis=-1)
    s = _A_ref(xn, A_w_r, A_w_i)
    g = _silu(_B_ref(xn, B_w1, B_w2))
    return x + s * g
```

```asm
; @launch kernel=k1_kernel grid=(256,1,1) block=(768,1,1) lds=154752
; @launch kernel=k2_kernel grid=(256,1,1) block=(768,1,1) lds=156672
; @launch kernel=k3_kernel grid=(224,1,1) block=(512,1,1) lds=123904
.amdgcn_target "amdgcn-amd-amdhsa--gfx950"
.text
.globl k1_kernel
.p2align 8
.type k1_kernel,@function
k1_kernel:
  s_cmp_ge_u32 s2, 256
  s_cbranch_scc1 Lend1
  s_load_dwordx2 s[8:9], s[0:1], 0
  s_load_dwordx2 s[12:13], s[0:1], 32
  s_load_dwordx2 s[6:7], s[0:1], 64
  v_lshrrev_b32 v2, 6, v0
  v_and_b32 v1, 63, v0
  v_readfirstlane_b32 s3, v2
  s_lshr_b32 s28, s2, 3
  s_and_b32 s20, s2, 3
  s_lshl_b32 s20, s20, 2
  s_and_b32 s29, s28, 3
  s_add_u32 s20, s20, s29
  s_lshr_b32 s21, s28, 2
  s_bfe_u32 s29, s2, 0x10002
  s_mul_i32 s30, s29, 6
  s_lshl_b32 s29, s29, 1
  s_add_u32 s29, s29, 6
  s_cmp_lt_u32 s21, 6
  s_cselect_b32 s29, s30, s29
  s_add_u32 s21, s21, s29
  s_mov_b32 s10, 0x1C0000
  s_mov_b32 s11, 0x20000
  s_mov_b32 s14, 1605632
  s_mov_b32 s15, 0x20000
  s_mov_b32 s38, 36864
  s_mov_b32 s39, -110592
  s_and_b32 s22, s3, 3
  s_mov_b32 s23, 3584
  s_waitcnt lgkmcnt(0)
  s_cmp_eq_u32 s21, 15
  s_cbranch_scc1 Lwt
  s_cmp_ge_u32 s21, 12
  s_cbranch_scc1 LisF
  s_cmp_ge_u32 s3, 4
  s_cbranch_scc0 LgW
  s_branch Lload
LisF:
  s_sub_u32 s21, s21, 12
  s_cmp_ge_u32 s3, 4
  s_cbranch_scc0 LgF
  s_mov_b32 s23, 896
  s_getpc_b64 s[12:13]
Lpc_k1:
  s_add_u32 s12, s12, ftab-Lpc_k1
  s_addc_u32 s13, s13, 0
  s_mov_b32 s14, 401408
  s_mov_b32 s15, 0x20000
Lload:
  s_cmp_ge_u32 s3, 8
  s_cbranch_scc1 Lstat
  v_lshrrev_b32 v2, 3, v1
  v_mul_u32_u24 v2, 28672, v2
  v_and_b32 v3, 7, v1
  v_lshrrev_b32 v4, 4, v1
  v_xor_b32 v3, v3, v4
  v_lshl_add_u32 v2, v3, 4, v2
  v_xor_b32 v3, 64, v2
  s_and_b32 s28, s22, 1
  s_lshl_b32 s28, s28, 10
  s_lshr_b32 s29, s22, 1
  s_add_u32 s28, s28, s29
  s_lshl_b32 s29, s20, 1
  s_add_u32 s28, s28, s29
  s_mul_i32 s24, s28, 896
  v_lshrrev_b32 v4, 2, v1
  v_mul_lo_u32 v4, s23, v4
  v_and_b32 v5, 3, v1
  v_lshl_add_u32 v4, v5, 4, v4
  s_mul_i32 s25, s22, s23
  s_lshl_b32 s25, s25, 4
  s_mul_i32 s28, s21, 320
  s_add_u32 s25, s25, s28
  s_lshl_b32 s26, s22, 12
  s_mul_i32 s29, s22, 5120
  s_add_u32 s29, s29, 16384
  s_lshl_b32 s23, s23, 6
  s_mov_b32 s27, 0
  s_and_b32 s28, s20, 3
  s_lshl_b32 s28, s28, 1
  s_lshr_b32 s30, s2, 5
  s_add_u32 s30, s28, s30
  s_mul_i32 s28, s30, 37
  s_lshr_b32 s28, s28, 8
  s_mul_i32 s28, s28, 7
  s_sub_u32 s30, s30, s28
  s_mul_i32 s30, s30, 1
  s_lshl_b32 s28, s30, 7
  s_add_u32 s24, s24, s28
  s_mul_i32 s28, s30, s23
  s_add_u32 s25, s25, s28
  s_mul_i32 s31, s23, 7
  s_add_u32 m0, s26, 0
  s_add_u32 s28, s24, 0
  buffer_load_dwordx4 v2, s[8:11], s28 offen lds
  s_add_u32 m0, s26, 1024
  s_add_u32 s28, s24, 229376
  buffer_load_dwordx4 v3, s[8:11], s28 offen lds
  s_add_u32 m0, s26, 2048
  s_add_u32 s28, s24, 458752
  buffer_load_dwordx4 v2, s[8:11], s28 offen lds
  s_add_u32 m0, s26, 3072
  s_add_u32 s28, s24, 688128
  buffer_load_dwordx4 v3, s[8:11], s28 offen lds
  s_add_u32 m0, s29, 0
  s_add_u32 s28, s25, 0
  buffer_load_dwordx4 v4, s[12:15], s28 offen lds
  s_add_u32 m0, s29, 1024
  s_add_u32 s28, s25, 64
  buffer_load_dwordx4 v4, s[12:15], s28 offen lds
  s_add_u32 m0, s29, 2048
  s_add_u32 s28, s25, 128
  buffer_load_dwordx4 v4, s[12:15], s28 offen lds
  s_add_u32 m0, s29, 3072
  s_add_u32 s28, s25, 192
  buffer_load_dwordx4 v4, s[12:15], s28 offen lds
  s_add_u32 m0, s29, 4096
  s_add_u32 s28, s25, 256
  buffer_load_dwordx4 v4, s[12:15], s28 offen lds
  s_add_u32 s27, s27, 1
  s_add_u32 s24, s24, 128
  s_add_u32 s25, s25, s23
  s_add_u32 s30, s30, 1
  s_cmp_eq_u32 s30, 7
  s_cselect_b32 s28, 896, 0
  s_cselect_b32 s32, s31, 0
  s_sub_u32 s24, s24, s28
  s_sub_u32 s25, s25, s32
  s_and_b32 s28, s27, 3
  s_cselect_b32 s28, s38, s39
  s_add_u32 s26, s26, s28
  s_add_u32 s29, s29, s28
  s_add_u32 m0, s26, 0
  s_add_u32 s28, s24, 0
  buffer_load_dwordx4 v2, s[8:11], s28 offen lds
  s_add_u32 m0, s26, 1024
  s_add_u32 s28, s24, 229376
  buffer_load_dwordx4 v3, s[8:11], s28 offen lds
  s_add_u32 m0, s26, 2048
  s_add_u32 s28, s24, 458752
  buffer_load_dwordx4 v2, s[8:11], s28 offen lds
  s_add_u32 m0, s26, 3072
  s_add_u32 s28, s24, 688128
  buffer_load_dwordx4 v3, s[8:11], s28 offen lds
  s_add_u32 m0, s29, 0
  s_add_u32 s28, s25, 0
  buffer_load_dwordx4 v4, s[12:15], s28 offen lds
  s_add_u32 m0, s29, 1024
  s_add_u32 s28, s25, 64
  buffer_load_dwordx4 v4, s[12:15], s28 offen lds
  s_add_u32 m0, s29, 2048
  s_add_u32 s28, s25, 128
  buffer_load_dwordx4 v4, s[12:15], s28 offen lds
  s_add_u32 m0, s29, 3072
  s_add_u32 s28, s25, 192
  buffer_load_dwordx4 v4, s[12:15], s28 offen lds
  s_add_u32 m0, s29, 4096
  s_add_u32 s28, s25, 256
  buffer_load_dwordx4 v4, s[12:15], s28 offen lds
  s_add_u32 s27, s27, 1
  s_add_u32 s24, s24, 128
  s_add_u32 s25, s25, s23
  s_add_u32 s30, s30, 1
  s_cmp_eq_u32 s30, 7
  s_cselect_b32 s28, 896, 0
  s_cselect_b32 s32, s31, 0
  s_sub_u32 s24, s24, s28
  s_sub_u32 s25, s25, s32
  s_and_b32 s28, s27, 3
  s_cselect_b32 s28, s38, s39
  s_add_u32 s26, s26, s28
  s_add_u32 s29, s29, s28
  s_waitcnt vmcnt(9)
  s_barrier
  s_add_u32 m0, s26, 0
  s_add_u32 s28, s24, 0
  buffer_load_dwordx4 v2, s[8:11], s28 offen lds
  s_add_u32 m0, s26, 1024
  s_add_u32 s28, s24, 229376
  buffer_load_dwordx4 v3, s[8:11], s28 offen lds
  s_add_u32 m0, s26, 2048
  s_add_u32 s28, s24, 458752
  buffer_load_dwordx4 v2, s[8:11], s28 offen lds
  s_add_u32 m0, s26, 3072
  s_add_u32 s28, s24, 688128
  buffer_load_dwordx4 v3, s[8:11], s28 offen lds
  s_add_u32 m0, s29, 0
  s_add_u32 s28, s25, 0
  buffer_load_dwordx4 v4, s[12:15], s28 offen lds
  s_add_u32 m0, s29, 1024
  s_add_u32 s28, s25, 64
  buffer_load_dwordx4 v4, s[12:15], s28 offen lds
  s_add_u32 m0, s29, 2048
  s_add_u32 s28, s25, 128
  buffer_load_dwordx4 v4, s[12:15], s28 offen lds
  s_add_u32 m0, s29, 3072
  s_add_u32 s28, s25, 192
  buffer_load_dwordx4 v4, s[12:15], s28 offen lds
  s_add_u32 m0, s29, 4096
  s_add_u32 s28, s25, 256
  buffer_load_dwordx4 v4, s[12:15], s28 offen lds
  s_add_u32 s27, s27, 1
  s_add_u32 s24, s24, 128
  s_add_u32 s25, s25, s23
  s_add_u32 s30, s30, 1
  s_cmp_eq_u32 s30, 7
  s_cselect_b32 s28, 896, 0
  s_cselect_b32 s32, s31, 0
  s_sub_u32 s24, s24, s28
  s_sub_u32 s25, s25, s32
  s_and_b32 s28, s27, 3
  s_cselect_b32 s28, s38, s39
  s_add_u32 s26, s26, s28
  s_add_u32 s29, s29, s28
  s_add_u32 m0, s26, 0
  s_add_u32 s28, s24, 0
  buffer_load_dwordx4 v2, s[8:11], s28 offen lds
  s_add_u32 m0, s26, 1024
  s_add_u32 s28, s24, 229376
  buffer_load_dwordx4 v3, s[8:11], s28 offen lds
  s_add_u32 m0, s26, 2048
  s_add_u32 s28, s24, 458752
  buffer_load_dwordx4 v2, s[8:11], s28 offen lds
  s_add_u32 m0, s26, 3072
  s_add_u32 s28, s24, 688128
  buffer_load_dwordx4 v3, s[8:11], s28 offen lds
  s_add_u32 m0, s29, 0
  s_add_u32 s28, s25, 0
  buffer_load_dwordx4 v4, s[12:15], s28 offen lds
  s_add_u32 m0, s29, 1024
  s_add_u32 s28, s25, 64
  buffer_load_dwordx4 v4, s[12:15], s28 offen lds
  s_add_u32 m0, s29, 2048
  s_add_u32 s28, s25, 128
  buffer_load_dwordx4 v4, s[12:15], s28 offen lds
  s_add_u32 m0, s29, 3072
  s_add_u32 s28, s25, 192
  buffer_load_dwordx4 v4, s[12:15], s28 offen lds
  s_add_u32 m0, s29, 4096
  s_add_u32 s28, s25, 256
  buffer_load_dwordx4 v4, s[12:15], s28 offen lds
  s_add_u32 s27, s27, 1
  s_add_u32 s24, s24, 128
  s_add_u32 s25, s25, s23
  s_add_u32 s30, s30, 1
  s_cmp_eq_u32 s30, 7
  s_cselect_b32 s28, 896, 0
  s_cselect_b32 s32, s31, 0
  s_sub_u32 s24, s24, s28
  s_sub_u32 s25, s25, s32
  s_and_b32 s28, s27, 3
  s_cselect_b32 s28, s38, s39
  s_add_u32 s26, s26, s28
  s_add_u32 s29, s29, s28
  s_waitcnt vmcnt(18)
  s_barrier
  s_add_u32 m0, s26, 0
  s_add_u32 s28, s24, 0
  buffer_load_dwordx4 v2, s[8:11], s28 offen lds
  s_add_u32 m0, s26, 1024
  s_add_u32 s28, s24, 229376
  buffer_load_dwordx4 v3, s[8:11], s28 offen lds
  s_add_u32 m0, s26, 2048
  s_add_u32 s28, s24, 458752
  buffer_load_dwordx4 v2, s[8:11], s28 offen lds
  s_add_u32 m0, s26, 3072
  s_add_u32 s28, s24, 688128
  buffer_load_dwordx4 v3, s[8:11], s28 offen lds
  s_add_u32 m0, s29, 0
  s_add_u32 s28, s25, 0
  buffer_load_dwordx4 v4, s[12:15], s28 offen lds
  s_add_u32 m0, s29, 1024
  s_add_u32 s28, s25, 64
  buffer_load_dwordx4 v4, s[12:15], s28 offen lds
  s_add_u32 m0, s29, 2048
  s_add_u32 s28, s25, 128
  buffer_load_dwordx4 v4, s[12:15], s28 offen lds
  s_add_u32 m0, s29, 3072
  s_add_u32 s28, s25, 192
  buffer_load_dwordx4 v4, s[12:15], s28 offen lds
  s_add_u32 m0, s29, 4096
  s_add_u32 s28, s25, 256
  buffer_load_dwordx4 v4, s[12:15], s28 offen lds
  s_add_u32 s27, s27, 1
  s_add_u32 s24, s24, 128
  s_add_u32 s25, s25, s23
  s_add_u32 s30, s30, 1
  s_cmp_eq_u32 s30, 7
  s_cselect_b32 s28, 896, 0
  s_cselect_b32 s32, s31, 0
  s_sub_u32 s24, s24, s28
  s_sub_u32 s25, s25, s32
  s_and_b32 s28, s27, 3
  s_cselect_b32 s28, s38, s39
  s_add_u32 s26, s26, s28
  s_add_u32 s29, s29, s28
  s_waitcnt vmcnt(18)
  s_barrier
  s_add_u32 m0, s26, 0
  s_add_u32 s28, s24, 0
  buffer_load_dwordx4 v2, s[8:11], s28 offen lds
  s_add_u32 m0, s26, 1024
  s_add_u32 s28, s24, 229376
  buffer_load_dwordx4 v3, s[8:11], s28 offen lds
  s_add_u32 m0, s26, 2048
  s_add_u32 s28, s24, 458752
  buffer_load_dwordx4 v2, s[8:11], s28 offen lds
  s_add_u32 m0, s26, 3072
  s_add_u32 s28, s24, 688128
  buffer_load_dwordx4 v3, s[8:11], s28 offen lds
  s_add_u32 m0, s29, 0
  s_add_u32 s28, s25, 0
  buffer_load_dwordx4 v4, s[12:15], s28 offen lds
  s_add_u32 m0, s29, 1024
  s_add_u32 s28, s25, 64
  buffer_load_dwordx4 v4, s[12:15], s28 offen lds
  s_add_u32 m0, s29, 2048
  s_add_u32 s28, s25, 128
  buffer_load_dwordx4 v4, s[12:15], s28 offen lds
  s_add_u32 m0, s29, 3072
  s_add_u32 s28, s25, 192
  buffer_load_dwordx4 v4, s[12:15], s28 offen lds
  s_add_u32 m0, s29, 4096
  s_add_u32 s28, s25, 256
  buffer_load_dwordx4 v4, s[12:15], s28 offen lds
  s_add_u32 s27, s27, 1
  s_add_u32 s24, s24, 128
  s_add_u32 s25, s25, s23
  s_add_u32 s30, s30, 1
  s_cmp_eq_u32 s30, 7
  s_cselect_b32 s28, 896, 0
  s_cselect_b32 s32, s31, 0
  s_sub_u32 s24, s24, s28
  s_sub_u32 s25, s25, s32
  s_and_b32 s28, s27, 3
  s_cselect_b32 s28, s38, s39
  s_add_u32 s26, s26, s28
  s_add_u32 s29, s29, s28
  s_waitcnt vmcnt(18)
  s_barrier
  s_add_u32 m0, s26, 0
  s_add_u32 s28, s24, 0
  buffer_load_dwordx4 v2, s[8:11], s28 offen lds
  s_add_u32 m0, s26, 1024
  s_add_u32 s28, s24, 229376
  buffer_load_dwordx4 v3, s[8:11], s28 offen lds
  s_add_u32 m0, s26, 2048
  s_add_u32 s28, s24, 458752
  buffer_load_dwordx4 v2, s[8:11], s28 offen lds
  s_add_u32 m0, s26, 3072
  s_add_u32 s28, s24, 688128
  buffer_load_dwordx4 v3, s[8:11], s28 offen lds
  s_add_u32 m0, s29, 0
  s_add_u32 s28, s25, 0
  buffer_load_dwordx4 v4, s[12:15], s28 offen lds
  s_add_u32 m0, s29, 1024
  s_add_u32 s28, s25, 64
  buffer_load_dwordx4 v4, s[12:15], s28 offen lds
  s_add_u32 m0, s29, 2048
  s_add_u32 s28, s25, 128
  buffer_load_dwordx4 v4, s[12:15], s28 offen lds
  s_add_u32 m0, s29, 3072
  s_add_u32 s28, s25, 192
  buffer_load_dwordx4 v4, s[12:15], s28 offen lds
  s_add_u32 m0, s29, 4096
  s_add_u32 s28, s25, 256
  buffer_load_dwordx4 v4, s[12:15], s28 offen lds
  s_add_u32 s27, s27, 1
  s_add_u32 s24, s24, 128
  s_add_u32 s25, s25, s23
  s_add_u32 s30, s30, 1
  s_cmp_eq_u32 s30, 7
  s_cselect_b32 s28, 896, 0
  s_cselect_b32 s32, s31, 0
  s_sub_u32 s24, s24, s28
  s_sub_u32 s25, s25, s32
  s_and_b32 s28, s27, 3
  s_cselect_b32 s28, s38, s39
  s_add_u32 s26, s26, s28
  s_add_u32 s29, s29, s28
  s_waitcnt vmcnt(18)
  s_barrier
  s_waitcnt vmcnt(9)
  s_barrier
  s_waitcnt vmcnt(0)
  s_barrier
  s_load_dwordx2 s[44:45], s[0:1], 40
  s_mov_b32 s46, 1605632
  s_mov_b32 s47, 0x20000
  s_lshr_b32 s28, s2, 3
  s_lshl_b32 s28, s28, 2
  s_add_u32 s28, s28, s22
  s_and_b32 s33, s28, 3
  s_mul_i32 s28, s28, 6272
  s_bitcmp1_b32 s2, 2
  s_cselect_b32 s29, 802816, 0
  s_add_u32 s28, s28, s29
  v_lshlrev_b32 v40, 7, v1
  s_getpc_b64 s[48:49]
Lpfl:
  s_add_u32 s48, s48, k2_kernel-Lpfl
  s_addc_u32 s49, s49, 0
  s_mov_b32 s50, ftab-k2_kernel
  s_mov_b32 s51, 0x20000
  s_lshl_b32 s33, s33, 13
  buffer_load_dword v42, v40, s[48:51], s33 offen
  v_cmp_gt_u32 vcc, 49, v1
  s_and_saveexec_b64 s[52:53], vcc
  s_waitcnt lgkmcnt(0)
  buffer_load_dword v41, v40, s[44:47], s28 offen
  s_mov_b64 exec, s[52:53]
  s_barrier
  s_barrier
  s_barrier
  s_waitcnt vmcnt(0)
  s_branch Lfin1
Lstat:
  s_lshl_b32 s28, s22, 12
  v_and_b32 v5, 31, v1
  v_lshrrev_b32 v6, 5, v1
  v_bfe_u32 v7, v5, 1, 3
  v_lshlrev_b32 v5, 7, v5
  v_add_u32 v5, s28, v5
  v_add_u32 v17, 0, v6
  v_xor_b32 v17, v17, v7
  v_lshl_add_u32 v8, v17, 4, v5
  v_add_u32 v17, 2, v6
  v_xor_b32 v17, v17, v7
  v_lshl_add_u32 v9, v17, 4, v5
  v_add_u32 v17, 4, v6
  v_xor_b32 v17, v17, v7
  v_lshl_add_u32 v10, v17, 4, v5
  v_add_u32 v17, 6, v6
  v_xor_b32 v17, v17, v7
  v_lshl_add_u32 v11, v17, 4, v5
  v_lshrrev_b32 v12, 5, v1
  v_bfe_u32 v17, v1, 2, 2
  v_lshl_add_u32 v12, v12, 3, v17
  v_lshlrev_b32 v12, 6, v12
  v_bfe_u32 v17, v1, 4, 1
  v_and_b32 v18, 3, v1
  v_lshl_add_u32 v17, v17, 2, v18
  v_lshlrev_b32 v17, 2, v17
  v_lshl_add_u32 v12, v17, 1, v12
  s_mul_i32 s31, s22, 5120
  s_add_u32 s31, s31, 16384
  v_add_u32 v12, s31, v12
  v_mov_b32 v79, 0x3f803f80
  v_mov_b32 v72, 0
  v_mov_b32 v73, 0
  v_mov_b32 v74, 0
  v_mov_b32 v75, 0
  v_mov_b32 v76, 0
  v_mov_b32 v77, 0
  v_mov_b32 v78, 0
  s_mov_b32 s41, 0xffff0000
  s_barrier
  ds_read_b128 v[24:27], v8
  ds_read_b128 v[28:31], v9
  ds_read_b128 v[32:35], v10
  ds_read_b128 v[36:39], v11
  ds_read_b64_tr_b16 v[40:41], v12 offset:0
  ds_read_b64_tr_b16 v[42:43], v12 offset:256
  ds_read_b64_tr_b16 v[44:45], v12 offset:1024
  ds_read_b64_tr_b16 v[46:47], v12 offset:1280
  ds_read_b64_tr_b16 v[48:49], v12 offset:2048
  ds_read_b64_tr_b16 v[50:51], v12 offset:2304
  ds_read_b64_tr_b16 v[52:53], v12 offset:3072
  ds_read_b64_tr_b16 v[54:55], v12 offset:3328
  ds_read_b64_tr_b16 v[56:57], v12 offset:4096
  ds_read_b64_tr_b16 v[58:59], v12 offset:4352
  v_add_u32 v8, s38, v8
  v_add_u32 v9, s38, v9
  v_add_u32 v10, s38, v10
  v_add_u32 v11, s38, v11
  v_add_u32 v12, s38, v12
  s_waitcnt lgkmcnt(0)
  v_dot2c_f32_bf16 v72, v24, v79
  v_dot2c_f32_bf16 v73, v24, v24
  v_dot2c_f32_bf16 v72, v25, v79
  v_dot2c_f32_bf16 v73, v25, v25
  v_dot2c_f32_bf16 v72, v26, v79
  v_dot2c_f32_bf16 v73, v26, v26
  v_dot2c_f32_bf16 v72, v27, v79
  v_dot2c_f32_bf16 v73, v27, v27
  v_dot2c_f32_bf16 v72, v28, v79
  v_dot2c_f32_bf16 v73, v28, v28
  v_dot2c_f32_bf16 v72, v29, v79
  v_dot2c_f32_bf16 v73, v29, v29
  v_dot2c_f32_bf16 v72, v30, v79
  v_dot2c_f32_bf16 v73, v30, v30
  v_dot2c_f32_bf16 v72, v31, v79
  v_dot2c_f32_bf16 v73, v31, v31
  v_dot2c_f32_bf16 v72, v32, v79
  v_dot2c_f32_bf16 v73, v32, v32
  v_dot2c_f32_bf16 v72, v33, v79
  v_dot2c_f32_bf16 v73, v33, v33
  v_dot2c_f32_bf16 v72, v34, v79
  v_dot2c_f32_bf16 v73, v34, v34
  v_dot2c_f32_bf16 v72, v35, v79
  v_dot2c_f32_bf16 v73, v35, v35
  v_dot2c_f32_bf16 v72, v36, v79
  v_dot2c_f32_bf16 v73, v36, v36
  v_dot2c_f32_bf16 v72, v37, v79
  v_dot2c_f32_bf16 v73, v37, v37
  v_dot2c_f32_bf16 v72, v38, v79
  v_dot2c_f32_bf16 v73, v38, v38
  v_dot2c_f32_bf16 v72, v39, v79
  v_dot2c_f32_bf16 v73, v39, v39
  v_dot2c_f32_bf16 v74, v40, v79
  v_dot2c_f32_bf16 v75, v44, v79
  v_dot2c_f32_bf16 v76, v48, v79
  v_dot2c_f32_bf16 v77, v52, v79
  v_dot2c_f32_bf16 v78, v56, v79
  v_dot2c_f32_bf16 v74, v41, v79
  v_dot2c_f32_bf16 v75, v45, v79
  v_dot2c_f32_bf16 v76, v49, v79
  v_dot2c_f32_bf16 v77, v53, v79
  v_dot2c_f32_bf16 v78, v57, v79
  v_dot2c_f32_bf16 v74, v42, v79
  v_dot2c_f32_bf16 v75, v46, v79
  v_dot2c_f32_bf16 v76, v50, v79
  v_dot2c_f32_bf16 v77, v54, v79
  v_dot2c_f32_bf16 v78, v58, v79
  v_dot2c_f32_bf16 v74, v43, v79
  v_dot2c_f32_bf16 v75, v47, v79
  v_dot2c_f32_bf16 v76, v51, v79
  v_dot2c_f32_bf16 v77, v55, v79
  v_dot2c_f32_bf16 v78, v59, v79
  s_barrier
  ds_read_b128 v[24:27], v8
  ds_read_b128 v[28:31], v9
  ds_read_b128 v[32:35], v10
  ds_read_b128 v[36:39], v11
  ds_read_b64_tr_b16 v[40:41], v12 offset:0
  ds_read_b64_tr_b16 v[42:43], v12 offset:256
  ds_read_b64_tr_b16 v[44:45], v12 offset:1024
  ds_read_b64_tr_b16 v[46:47], v12 offset:1280
  ds_read_b64_tr_b16 v[48:49], v12 offset:2048
  ds_read_b64_tr_b16 v[50:51], v12 offset:2304
  ds_read_b64_tr_b16 v[52:53], v12 offset:3072
  ds_read_b64_tr_b16 v[54:55], v12 offset:3328
  ds_read_b64_tr_b16 v[56:57], v12 offset:4096
  ds_read_b64_tr_b16 v[58:59], v12 offset:4352
  v_add_u32 v8, s38, v8
  v_add_u32 v9, s38, v9
  v_add_u32 v10, s38, v10
  v_add_u32 v11, s38, v11
  v_add_u32 v12, s38, v12
  s_waitcnt lgkmcnt(0)
  v_dot2c_f32_bf16 v72, v24, v79
  v_dot2c_f32_bf16 v73, v24, v24
  v_dot2c_f32_bf16 v72, v25, v79
  v_dot2c_f32_bf16 v73, v25, v25
  v_dot2c_f32_bf16 v72, v26, v79
  v_dot2c_f32_bf16 v73, v26, v26
  v_dot2c_f32_bf16 v72, v27, v79
  v_dot2c_f32_bf16 v73, v27, v27
  v_dot2c_f32_bf16 v72, v28, v79
  v_dot2c_f32_bf16 v73, v28, v28
  v_dot2c_f32_bf16 v72, v29, v79
  v_dot2c_f32_bf16 v73, v29, v29
  v_dot2c_f32_bf16 v72, v30, v79
  v_dot2c_f32_bf16 v73, v30, v30
  v_dot2c_f32_bf16 v72, v31, v79
  v_dot2c_f32_bf16 v73, v31, v31
  v_dot2c_f32_bf16 v72, v32, v79
  v_dot2c_f32_bf16 v73, v32, v32
  v_dot2c_f32_bf16 v72, v33, v79
  v_dot2c_f32_bf16 v73, v33, v33
  v_dot2c_f32_bf16 v72, v34, v79
  v_dot2c_f32_bf16 v73, v34, v34
  v_dot2c_f32_bf16 v72, v35, v79
  v_dot2c_f32_bf16 v73, v35, v35
  v_dot2c_f32_bf16 v72, v36, v79
  v_dot2c_f32_bf16 v73, v36, v36
  v_dot2c_f32_bf16 v72, v37, v79
  v_dot2c_f32_bf16 v73, v37, v37
  v_dot2c_f32_bf16 v72, v38, v79
  v_dot2c_f32_bf16 v73, v38, v38
  v_dot2c_f32_bf16 v72, v39, v79
  v_dot2c_f32_bf16 v73, v39, v39
  v_dot2c_f32_bf16 v74, v40, v79
  v_dot2c_f32_bf16 v75, v44, v79
  v_dot2c_f32_bf16 v76, v48, v79
  v_dot2c_f32_bf16 v77, v52, v79
  v_dot2c_f32_bf16 v78, v56, v79
  v_dot2c_f32_bf16 v74, v41, v79
  v_dot2c_f32_bf16 v75, v45, v79
  v_dot2c_f32_bf16 v76, v49, v79
  v_dot2c_f32_bf16 v77, v53, v79
  v_dot2c_f32_bf16 v78, v57, v79
  v_dot2c_f32_bf16 v74, v42, v79
  v_dot2c_f32_bf16 v75, v46, v79
  v_dot2c_f32_bf16 v76, v50, v79
  v_dot2c_f32_bf16 v77, v54, v79
  v_dot2c_f32_bf16 v78, v58, v79
  v_dot2c_f32_bf16 v74, v43, v79
  v_dot2c_f32_bf16 v75, v47, v79
  v_dot2c_f32_bf16 v76, v51, v79
  v_dot2c_f32_bf16 v77, v55, v79
  v_dot2c_f32_bf16 v78, v59, v79
  s_barrier
  ds_read_b128 v[24:27], v8
  ds_read_b128 v[28:31], v9
  ds_read_b128 v[32:35], v10
  ds_read_b128 v[36:39], v11
  ds_read_b64_tr_b16 v[40:41], v12 offset:0
  ds_read_b64_tr_b16 v[42:43], v12 offset:256
  ds_read_b64_tr_b16 v[44:45], v12 offset:1024
  ds_read_b64_tr_b16 v[46:47], v12 offset:1280
  ds_read_b64_tr_b16 v[48:49], v12 offset:2048
  ds_read_b64_tr_b16 v[50:51], v12 offset:2304
  ds_read_b64_tr_b16 v[52:53], v12 offset:3072
  ds_read_b64_tr_b16 v[54:55], v12 offset:3328
  ds_read_b64_tr_b16 v[56:57], v12 offset:4096
  ds_read_b64_tr_b16 v[58:59], v12 offset:4352
  v_add_u32 v8, s38, v8
  v_add_u32 v9, s38, v9
  v_add_u32 v10, s38, v10
  v_add_u32 v11, s38, v11
  v_add_u32 v12, s38, v12
  s_waitcnt lgkmcnt(0)
  v_dot2c_f32_bf16 v72, v24, v79
  v_dot2c_f32_bf16 v73, v24, v24
  v_dot2c_f32_bf16 v72, v25, v79
  v_dot2c_f32_bf16 v73, v25, v25
  v_dot2c_f32_bf16 v72, v26, v79
  v_dot2c_f32_bf16 v73, v26, v26
  v_dot2c_f32_bf16 v72, v27, v79
  v_dot2c_f32_bf16 v73, v27, v27
  v_dot2c_f32_bf16 v72, v28, v79
  v_dot2c_f32_bf16 v73, v28, v28
  v_dot2c_f32_bf16 v72, v29, v79
  v_dot2c_f32_bf16 v73, v29, v29
  v_dot2c_f32_bf16 v72, v30, v79
  v_dot2c_f32_bf16 v73, v30, v30
  v_dot2c_f32_bf16 v72, v31, v79
  v_dot2c_f32_bf16 v73, v31, v31
  v_dot2c_f32_bf16 v72, v32, v79
  v_dot2c_f32_bf16 v73, v32, v32
  v_dot2c_f32_bf16 v72, v33, v79
  v_dot2c_f32_bf16 v73, v33, v33
  v_dot2c_f32_bf16 v72, v34, v79
  v_dot2c_f32_bf16 v73, v34, v34
  v_dot2c_f32_bf16 v72, v35, v79
  v_dot2c_f32_bf16 v73, v35, v35
  v_dot2c_f32_bf16 v72, v36, v79
  v_dot2c_f32_bf16 v73, v36, v36
  v_dot2c_f32_bf16 v72, v37, v79
  v_dot2c_f32_bf16 v73, v37, v37
  v_dot2c_f32_bf16 v72, v38, v79
  v_dot2c_f32_bf16 v73, v38, v38
  v_dot2c_f32_bf16 v72, v39, v79
  v_dot2c_f32_bf16 v73, v39, v39
  v_dot2c_f32_bf16 v74, v40, v79
  v_dot2c_f32_bf16 v75, v44, v79
  v_dot2c_f32_bf16 v76, v48, v79
  v_dot2c_f32_bf16 v77, v52, v79
  v_dot2c_f32_bf16 v78, v56, v79
  v_dot2c_f32_bf16 v74, v41, v79
  v_dot2c_f32_bf16 v75, v45, v79
  v_dot2c_f32_bf16 v76, v49, v79
  v_dot2c_f32_bf16 v77, v53, v79
  v_dot2c_f32_bf16 v78, v57, v79
  v_dot2c_f32_bf16 v74, v42, v79
  v_dot2c_f32_bf16 v75, v46, v79
  v_dot2c_f32_bf16 v76, v50, v79
  v_dot2c_f32_bf16 v77, v54, v79
  v_dot2c_f32_bf16 v78, v58, v79
  v_dot2c_f32_bf16 v74, v43, v79
  v_dot2c_f32_bf16 v75, v47, v79
  v_dot2c_f32_bf16 v76, v51, v79
  v_dot2c_f32_bf16 v77, v55, v79
  v_dot2c_f32_bf16 v78, v59, v79
  s_barrier
  ds_read_b128 v[24:27], v8
  ds_read_b128 v[28:31], v9
  ds_read_b128 v[32:35], v10
  ds_read_b128 v[36:39], v11
  ds_read_b64_tr_b16 v[40:41], v12 offset:0
  ds_read_b64_tr_b16 v[42:43], v12 offset:256
  ds_read_b64_tr_b16 v[44:45], v12 offset:1024
  ds_read_b64_tr_b16 v[46:47], v12 offset:1280
  ds_read_b64_tr_b16 v[48:49], v12 offset:2048
  ds_read_b64_tr_b16 v[50:51], v12 offset:2304
  ds_read_b64_tr_b16 v[52:53], v12 offset:3072
  ds_read_b64_tr_b16 v[54:55], v12 offset:3328
  ds_read_b64_tr_b16 v[56:57], v12 offset:4096
  ds_read_b64_tr_b16 v[58:59], v12 offset:4352
  v_add_u32 v8, s39, v8
  v_add_u32 v9, s39, v9
  v_add_u32 v10, s39, v10
  v_add_u32 v11, s39, v11
  v_add_u32 v12, s39, v12
  s_waitcnt lgkmcnt(0)
  v_dot2c_f32_bf16 v72, v24, v79
  v_dot2c_f32_bf16 v73, v24, v24
  v_dot2c_f32_bf16 v72, v25, v79
  v_dot2c_f32_bf16 v73, v25, v25
  v_dot2c_f32_bf16 v72, v26, v79
  v_dot2c_f32_bf16 v73, v26, v26
  v_dot2c_f32_bf16 v72, v27, v79
  v_dot2c_f32_bf16 v73, v27, v27
  v_dot2c_f32_bf16 v72, v28, v79
  v_dot2c_f32_bf16 v73, v28, v28
  v_dot2c_f32_bf16 v72, v29, v79
  v_dot2c_f32_bf16 v73, v29, v29
  v_dot2c_f32_bf16 v72, v30, v79
  v_dot2c_f32_bf16 v73, v30, v30
  v_dot2c_f32_bf16 v72, v31, v79
  v_dot2c_f32_bf16 v73, v31, v31
  v_dot2c_f32_bf16 v72, v32, v79
  v_dot2c_f32_bf16 v73, v32, v32
  v_dot2c_f32_bf16 v72, v33, v79
  v_dot2c_f32_bf16 v73, v33, v33
  v_dot2c_f32_bf16 v72, v34, v79
  v_dot2c_f32_bf16 v73, v34, v34
  v_dot2c_f32_bf16 v72, v35, v79
  v_dot2c_f32_bf16 v73, v35, v35
  v_dot2c_f32_bf16 v72, v36, v79
  v_dot2c_f32_bf16 v73, v36, v36
  v_dot2c_f32_bf16 v72, v37, v79
  v_dot2c_f32_bf16 v73, v37, v37
  v_dot2c_f32_bf16 v72, v38, v79
  v_dot2c_f32_bf16 v73, v38, v38
  v_dot2c_f32_bf16 v72, v39, v79
  v_dot2c_f32_bf16 v73, v39, v39
  v_dot2c_f32_bf16 v74, v40, v79
  v_dot2c_f32_bf16 v75, v44, v79
  v_dot2c_f32_bf16 v76, v48, v79
  v_dot2c_f32_bf16 v77, v52, v79
  v_dot2c_f32_bf16 v78, v56, v79
  v_dot2c_f32_bf16 v74, v41, v79
  v_dot2c_f32_bf16 v75, v45, v79
  v_dot2c_f32_bf16 v76, v49, v79
  v_dot2c_f32_bf16 v77, v53, v79
  v_dot2c_f32_bf16 v78, v57, v79
  v_dot2c_f32_bf16 v74, v42, v79
  v_dot2c_f32_bf16 v75, v46, v79
  v_dot2c_f32_bf16 v76, v50, v79
  v_dot2c_f32_bf16 v77, v54, v79
  v_dot2c_f32_bf16 v78, v58, v79
  v_dot2c_f32_bf16 v74, v43, v79
  v_dot2c_f32_bf16 v75, v47, v79
  v_dot2c_f32_bf16 v76, v51, v79
  v_dot2c_f32_bf16 v77, v55, v79
  v_dot2c_f32_bf16 v78, v59, v79
  s_barrier
  ds_read_b128 v[24:27], v8
  ds_read_b128 v[28:31], v9
  ds_read_b128 v[32:35], v10
  ds_read_b128 v[36:39], v11
  ds_read_b64_tr_b16 v[40:41], v12 offset:0
  ds_read_b64_tr_b16 v[42:43], v12 offset:256
  ds_read_b64_tr_b16 v[44:45], v12 offset:1024
  ds_read_b64_tr_b16 v[46:47], v12 offset:1280
  ds_read_b64_tr_b16 v[48:49], v12 offset:2048
  ds_read_b64_tr_b16 v[50:51], v12 offset:2304
  ds_read_b64_tr_b16 v[52:53], v12 offset:3072
  ds_read_b64_tr_b16 v[54:55], v12 offset:3328
  ds_read_b64_tr_b16 v[56:57], v12 offset:4096
  ds_read_b64_tr_b16 v[58:59], v12 offset:4352
  v_add_u32 v8, s38, v8
  v_add_u32 v9, s38, v9
  v_add_u32 v10, s38, v10
  v_add_u32 v11, s38, v11
  v_add_u32 v12, s38, v12
  s_waitcnt lgkmcnt(0)
  v_dot2c_f32_bf16 v72, v24, v79
  v_dot2c_f32_bf16 v73, v24, v24
  v_dot2c_f32_bf16 v72, v25, v79
  v_dot2c_f32_bf16 v73, v25, v25
  v_dot2c_f32_bf16 v72, v26, v79
  v_dot2c_f32_bf16 v73, v26, v26
  v_dot2c_f32_bf16 v72, v27, v79
  v_dot2c_f32_bf16 v73, v27, v27
  v_dot2c_f32_bf16 v72, v28, v79
  v_dot2c_f32_bf16 v73, v28, v28
  v_dot2c_f32_bf16 v72, v29, v79
  v_dot2c_f32_bf16 v73, v29, v29
  v_dot2c_f32_bf16 v72, v30, v79
  v_dot2c_f32_bf16 v73, v30, v30
  v_dot2c_f32_bf16 v72, v31, v79
  v_dot2c_f32_bf16 v73, v31, v31
  v_dot2c_f32_bf16 v72, v32, v79
  v_dot2c_f32_bf16 v73, v32, v32
  v_dot2c_f32_bf16 v72, v33, v79
  v_dot2c_f32_bf16 v73, v33, v33
  v_dot2c_f32_bf16 v72, v34, v79
  v_dot2c_f32_bf16 v73, v34, v34
  v_dot2c_f32_bf16 v72, v35, v79
  v_dot2c_f32_bf16 v73, v35, v35
  v_dot2c_f32_bf16 v72, v36, v79
  v_dot2c_f32_bf16 v73, v36, v36
  v_dot2c_f32_bf16 v72, v37, v79
  v_dot2c_f32_bf16 v73, v37, v37
  v_dot2c_f32_bf16 v72, v38, v79
  v_dot2c_f32_bf16 v73, v38, v38
  v_dot2c_f32_bf16 v72, v39, v79
  v_dot2c_f32_bf16 v73, v39, v39
  v_dot2c_f32_bf16 v74, v40, v79
  v_dot2c_f32_bf16 v75, v44, v79
  v_dot2c_f32_bf16 v76, v48, v79
  v_dot2c_f32_bf16 v77, v52, v79
  v_dot2c_f32_bf16 v78, v56, v79
  v_dot2c_f32_bf16 v74, v41, v79
  v_dot2c_f32_bf16 v75, v45, v79
  v_dot2c_f32_bf16 v76, v49, v79
  v_dot2c_f32_bf16 v77, v53, v79
  v_dot2c_f32_bf16 v78, v57, v79
  v_dot2c_f32_bf16 v74, v42, v79
  v_dot2c_f32_bf16 v75, v46, v79
  v_dot2c_f32_bf16 v76, v50, v79
  v_dot2c_f32_bf16 v77, v54, v79
  v_dot2c_f32_bf16 v78, v58, v79
  v_dot2c_f32_bf16 v74, v43, v79
  v_dot2c_f32_bf16 v75, v47, v79
  v_dot2c_f32_bf16 v76, v51, v79
  v_dot2c_f32_bf16 v77, v55, v79
  v_dot2c_f32_bf16 v78, v59, v79
  s_barrier
  ds_read_b128 v[24:27], v8
  ds_read_b128 v[28:31], v9
  ds_read_b128 v[32:35], v10
  ds_read_b128 v[36:39], v11
  ds_read_b64_tr_b16 v[40:41], v12 offset:0
  ds_read_b64_tr_b16 v[42:43], v12 offset:256
  ds_read_b64_tr_b16 v[44:45], v12 offset:1024
  ds_read_b64_tr_b16 v[46:47], v12 offset:1280
  ds_read_b64_tr_b16 v[48:49], v12 offset:2048
  ds_read_b64_tr_b16 v[50:51], v12 offset:2304
  ds_read_b64_tr_b16 v[52:53], v12 offset:3072
  ds_read_b64_tr_b16 v[54:55], v12 offset:3328
  ds_read_b64_tr_b16 v[56:57], v12 offset:4096
  ds_read_b64_tr_b16 v[58:59], v12 offset:4352
  v_add_u32 v8, s38, v8
  v_add_u32 v9, s38, v9
  v_add_u32 v10, s38, v10
  v_add_u32 v11, s38, v11
  v_add_u32 v12, s38, v12
  s_waitcnt lgkmcnt(0)
  v_dot2c_f32_bf16 v72, v24, v79
  v_dot2c_f32_bf16 v73, v24, v24
  v_dot2c_f32_bf16 v72, v25, v79
  v_dot2c_f32_bf16 v73, v25, v25
  v_dot2c_f32_bf16 v72, v26, v79
  v_dot2c_f32_bf16 v73, v26, v26
  v_dot2c_f32_bf16 v72, v27, v79
  v_dot2c_f32_bf16 v73, v27, v27
  v_dot2c_f32_bf16 v72, v28, v79
  v_dot2c_f32_bf16 v73, v28, v28
  v_dot2c_f32_bf16 v72, v29, v79
  v_dot2c_f32_bf16 v73, v29, v29
  v_dot2c_f32_bf16 v72, v30, v79
  v_dot2c_f32_bf16 v73, v30, v30
  v_dot2c_f32_bf16 v72, v31, v79
  v_dot2c_f32_bf16 v73, v31, v31
  v_dot2c_f32_bf16 v72, v32, v79
  v_dot2c_f32_bf16 v73, v32, v32
  v_dot2c_f32_bf16 v72, v33, v79
  v_dot2c_f32_bf16 v73, v33, v33
  v_dot2c_f32_bf16 v72, v34, v79
  v_dot2c_f32_bf16 v73, v34, v34
  v_dot2c_f32_bf16 v72, v35, v79
  v_dot2c_f32_bf16 v73, v35, v35
  v_dot2c_f32_bf16 v72, v36, v79
  v_dot2c_f32_bf16 v73, v36, v36
  v_dot2c_f32_bf16 v72, v37, v79
  v_dot2c_f32_bf16 v73, v37, v37
  v_dot2c_f32_bf16 v72, v38, v79
  v_dot2c_f32_bf16 v73, v38, v38
  v_dot2c_f32_bf16 v72, v39, v79
  v_dot2c_f32_bf16 v73, v39, v39
  v_dot2c_f32_bf16 v74, v40, v79
  v_dot2c_f32_bf16 v75, v44, v79
  v_dot2c_f32_bf16 v76, v48, v79
  v_dot2c_f32_bf16 v77, v52, v79
  v_dot2c_f32_bf16 v78, v56, v79
  v_dot2c_f32_bf16 v74, v41, v79
  v_dot2c_f32_bf16 v75, v45, v79
  v_dot2c_f32_bf16 v76, v49, v79
  v_dot2c_f32_bf16 v77, v53, v79
  v_dot2c_f32_bf16 v78, v57, v79
  v_dot2c_f32_bf16 v74, v42, v79
  v_dot2c_f32_bf16 v75, v46, v79
  v_dot2c_f32_bf16 v76, v50, v79
  v_dot2c_f32_bf16 v77, v54, v79
  v_dot2c_f32_bf16 v78, v58, v79
  v_dot2c_f32_bf16 v74, v43, v79
  v_dot2c_f32_bf16 v75, v47, v79
  v_dot2c_f32_bf16 v76, v51, v79
  v_dot2c_f32_bf16 v77, v55, v79
  v_dot2c_f32_bf16 v78, v59, v79
  s_barrier
  ds_read_b128 v[24:27], v8
  ds_read_b128 v[28:31], v9
  ds_read_b128 v[32:35], v10
  ds_read_b128 v[36:39], v11
  ds_read_b64_tr_b16 v[40:41], v12 offset:0
  ds_read_b64_tr_b16 v[42:43], v12 offset:256
  ds_read_b64_tr_b16 v[44:45], v12 offset:1024
  ds_read_b64_tr_b16 v[46:47], v12 offset:1280
  ds_read_b64_tr_b16 v[48:49], v12 offset:2048
  ds_read_b64_tr_b16 v[50:51], v12 offset:2304
  ds_read_b64_tr_b16 v[52:53], v12 offset:3072
  ds_read_b64_tr_b16 v[54:55], v12 offset:3328
  ds_read_b64_tr_b16 v[56:57], v12 offset:4096
  ds_read_b64_tr_b16 v[58:59], v12 offset:4352
  s_waitcnt lgkmcnt(0)
  v_dot2c_f32_bf16 v72, v24, v79
  v_dot2c_f32_bf16 v73, v24, v24
  v_dot2c_f32_bf16 v72, v25, v79
  v_dot2c_f32_bf16 v73, v25, v25
  v_dot2c_f32_bf16 v72, v26, v79
  v_dot2c_f32_bf16 v73, v26, v26
  v_dot2c_f32_bf16 v72, v27, v79
  v_dot2c_f32_bf16 v73, v27, v27
  v_dot2c_f32_bf16 v72, v28, v79
  v_dot2c_f32_bf16 v73, v28, v28
  v_dot2c_f32_bf16 v72, v29, v79
  v_dot2c_f32_bf16 v73, v29, v29
  v_dot2c_f32_bf16 v72, v30, v79
  v_dot2c_f32_bf16 v73, v30, v30
  v_dot2c_f32_bf16 v72, v31, v79
  v_dot2c_f32_bf16 v73, v31, v31
  v_dot2c_f32_bf16 v72, v32, v79
  v_dot2c_f32_bf16 v73, v32, v32
  v_dot2c_f32_bf16 v72, v33, v79
  v_dot2c_f32_bf16 v73, v33, v33
  v_dot2c_f32_bf16 v72, v34, v79
  v_dot2c_f32_bf16 v73, v34, v34
  v_dot2c_f32_bf16 v72, v35, v79
  v_dot2c_f32_bf16 v73, v35, v35
  v_dot2c_f32_bf16 v72, v36, v79
  v_dot2c_f32_bf16 v73, v36, v36
  v_dot2c_f32_bf16 v72, v37, v79
  v_dot2c_f32_bf16 v73, v37, v37
  v_dot2c_f32_bf16 v72, v38, v79
  v_dot2c_f32_bf16 v73, v38, v38
  v_dot2c_f32_bf16 v72, v39, v79
  v_dot2c_f32_bf16 v73, v39, v39
  v_dot2c_f32_bf16 v74, v40, v79
  v_dot2c_f32_bf16 v75, v44, v79
  v_dot2c_f32_bf16 v76, v48, v79
  v_dot2c_f32_bf16 v77, v52, v79
  v_dot2c_f32_bf16 v78, v56, v79
  v_dot2c_f32_bf16 v74, v41, v79
  v_dot2c_f32_bf16 v75, v45, v79
  v_dot2c_f32_bf16 v76, v49, v79
  v_dot2c_f32_bf16 v77, v53, v79
  v_dot2c_f32_bf16 v78, v57, v79
  v_dot2c_f32_bf16 v74, v42, v79
  v_dot2c_f32_bf16 v75, v46, v79
  v_dot2c_f32_bf16 v76, v50, v79
  v_dot2c_f32_bf16 v77, v54, v79
  v_dot2c_f32_bf16 v78, v58, v79
  v_dot2c_f32_bf16 v74, v43, v79
  v_dot2c_f32_bf16 v75, v47, v79
  v_dot2c_f32_bf16 v76, v51, v79
  v_dot2c_f32_bf16 v77, v55, v79
  v_dot2c_f32_bf16 v78, v59, v79
  v_lshrrev_b32 v6, 5, v1
  s_lshl_b32 s28, s22, 1
  v_add_u32 v6, s28, v6
  v_mul_u32_u24 v6, 640, v6
  v_and_b32 v5, 31, v1
  v_lshl_add_u32 v6, v5, 2, v6
  v_add_u32 v6, 147456, v6
  ds_write_b32 v6, v74 offset:0
  ds_write_b32 v6, v75 offset:128
  ds_write_b32 v6, v76 offset:256
  ds_write_b32 v6, v77 offset:384
  ds_write_b32 v6, v78 offset:512
  v_mov_b32 v20, v72
  v_mov_b32 v21, v73
  s_nop 1
  v_permlane32_swap_b32 v72, v20
  v_permlane32_swap_b32 v73, v21
  s_nop 1
  v_add_f32 v72, v72, v20
  v_add_f32 v73, v73, v21
  v_mul_f32 v72, 0x3b124925, v72
  v_mul_f32 v73, 0x3b124925, v73
  v_fma_f32 v73, -v72, v72, v73
  v_max_f32 v73, 0, v73
  v_cvt_pk_bf16_f32 v72, v72, v73
  v_and_b32 v73, 0xffff0000, v72
  v_lshlrev_b32 v72, 16, v72
  v_add_f32 v73, 0x3727c5ac, v73
  v_cvt_pk_bf16_f32 v73, v73, v73
  v_and_b32 v73, 0xffff0000, v73
  v_sqrt_f32 v73, v73
  s_waitcnt lgkmcnt(0)
  s_barrier
  v_cvt_pk_bf16_f32 v73, v73, v73
  v_and_b32 v73, 0xffff0000, v73
  v_rcp_f32 v76, v73
  v_and_b32 v6, 255, v0
  v_lshlrev_b32 v6, 2, v6
  v_add_u32 v7, 147456, v6
  ds_read_b32 v24, v7 offset:0
  ds_read_b32 v25, v7 offset:640
  ds_read_b32 v26, v7 offset:1280
  ds_read_b32 v27, v7 offset:1920
  ds_read_b32 v28, v7 offset:2560
  ds_read_b32 v29, v7 offset:3200
  ds_read_b32 v30, v7 offset:3840
  ds_read_b32 v31, v7 offset:4480
  v_mul_f32 v77, v76, v72
  s_mul_i32 s28, s22, 384
  s_add_u32 s28, s28, 153216
  v_lshl_add_u32 v5, v5, 2, s28
  ds_write_b32 v5, v76
  ds_write_b32 v5, v77 offset:128
  ds_write_b32 v5, v72 offset:256
  s_waitcnt lgkmcnt(3)
  v_add_f32 v24, v24, v25
  v_add_f32 v26, v26, v27
  v_add_f32 v28, v28, v29
  v_add_f32 v30, v30, v31
  v_add_f32 v24, v24, v26
  v_add_f32 v28, v28, v30
  v_add_f32 v24, v24, v28
  v_cmp_gt_u32 vcc, 640, v6
  s_and_saveexec_b64 s[36:37], vcc
  v_add_u32 v7, 152576, v6
  ds_write_b32 v7, v24
  s_mov_b64 exec, s[36:37]
  s_waitcnt vmcnt(0) lgkmcnt(0)
  s_barrier
  s_barrier
  s_branch Lfin1
LgW:
  s_getpc_b64 s[48:49]
LcpW:
  s_sub_u32 s48, s48, LcpW-k1_kernel
  s_subb_u32 s49, s49, 0
  s_mov_b32 s50, k2_kernel-k1_kernel
  s_mov_b32 s51, 0x20000
  s_lshl_b32 s33, s22, 13
  v_lshlrev_b32 v20, 7, v1
  buffer_load_dword v21, v20, s[48:51], s33 offen
  s_mov_b32 s16, s6
  s_mov_b32 s17, s7
  s_mov_b32 s18, 0x700000
  s_mov_b32 s19, 0x20000
  s_lshl_b32 s28, s22, 12
  v_and_b32 v5, 31, v1
  v_lshrrev_b32 v6, 5, v1
  v_bfe_u32 v7, v5, 1, 3
  v_lshlrev_b32 v5, 7, v5
  v_add_u32 v5, s28, v5
  v_add_u32 v17, 0, v6
  v_xor_b32 v17, v17, v7
  v_lshl_add_u32 v8, v17, 4, v5
  v_add_u32 v17, 2, v6
  v_xor_b32 v17, v17, v7
  v_lshl_add_u32 v9, v17, 4, v5
  v_add_u32 v17, 4, v6
  v_xor_b32 v17, v17, v7
  v_lshl_add_u32 v10, v17, 4, v5
  v_add_u32 v17, 6, v6
  v_xor_b32 v17, v17, v7
  v_lshl_add_u32 v11, v17, 4, v5
  v_lshrrev_b32 v12, 5, v1
  v_bfe_u32 v17, v1, 2, 2
  v_lshl_add_u32 v12, v12, 3, v17
  v_lshlrev_b32 v12, 6, v12
  v_bfe_u32 v17, v1, 4, 1
  v_and_b32 v18, 3, v1
  v_lshl_add_u32 v17, v17, 2, v18
  v_lshlrev_b32 v17, 2, v17
  v_lshrrev_b32 v18, 1, v17
  v_xor_b32 v18, v18, v17
  v_and_b32 v18, 4, v18
  v_mul_u32_u24 v18, 3, v18
  v_xor_b32 v17, v17, v18
  v_lshl_add_u32 v12, v17, 1, v12
  v_add_u32 v12, 16384, v12
  v_mov_b32 v80, 0
  v_mov_b32 v81, 0
  v_mov_b32 v82, 0
  v_mov_b32 v83, 0
  v_mov_b32 v84, 0
  v_mov_b32 v85, 0
  v_mov_b32 v86, 0
  v_mov_b32 v87, 0
  v_mov_b32 v88, 0
  v_mov_b32 v89, 0
  v_mov_b32 v90, 0
  v_mov_b32 v91, 0
  v_mov_b32 v92, 0
  v_mov_b32 v93, 0
  v_mov_b32 v94, 0
  v_mov_b32 v95, 0
  v_mov_b32 v96, 0
  v_mov_b32 v97, 0
  v_mov_b32 v98, 0
  v_mov_b32 v99, 0
  v_mov_b32 v100, 0
  v_mov_b32 v101, 0
  v_mov_b32 v102, 0
  v_mov_b32 v103, 0
  v_mov_b32 v104, 0
  v_mov_b32 v105, 0
  v_mov_b32 v106, 0
  v_mov_b32 v107, 0
  v_mov_b32 v108, 0
  v_mov_b32 v109, 0
  v_mov_b32 v110, 0
  v_mov_b32 v111, 0
  v_mov_b32 v112, 0
  v_mov_b32 v113, 0
  v_mov_b32 v114, 0
  v_mov_b32 v115, 0
  v_mov_b32 v116, 0
  v_mov_b32 v117, 0
  v_mov_b32 v118, 0
  v_mov_b32 v119, 0
  v_mov_b32 v120, 0
  v_mov_b32 v121, 0
  v_mov_b32 v122, 0
  v_mov_b32 v123, 0
  v_mov_b32 v124, 0
  v_mov_b32 v125, 0
  v_mov_b32 v126, 0
  v_mov_b32 v127, 0
  v_mov_b32 v128, 0
  v_mov_b32 v129, 0
  v_mov_b32 v130, 0
  v_mov_b32 v131, 0
  v_mov_b32 v132, 0
  v_mov_b32 v133, 0
  v_mov_b32 v134, 0
  v_mov_b32 v135, 0
  v_mov_b32 v136, 0
  v_mov_b32 v137, 0
  v_mov_b32 v138, 0
  v_mov_b32 v139, 0
  v_mov_b32 v140, 0
  v_mov_b32 v141, 0
  v_mov_b32 v142, 0
  v_mov_b32 v143, 0
  v_mov_b32 v144, 0
  v_mov_b32 v145, 0
  v_mov_b32 v146, 0
  v_mov_b32 v147, 0
  v_mov_b32 v148, 0
  v_mov_b32 v149, 0
  v_mov_b32 v150, 0
  v_mov_b32 v151, 0
  v_mov_b32 v152, 0
  v_mov_b32 v153, 0
  v_mov_b32 v154, 0
  v_mov_b32 v155, 0
  v_mov_b32 v156, 0
  v_mov_b32 v157, 0
  v_mov_b32 v158, 0
  v_mov_b32 v159, 0
  s_mov_b32 s30, 0
  s_barrier
  ds_read_b128 v[24:27], v8
  ds_read_b64_tr_b16 v[32:33], v12 offset:0
  ds_read_b64_tr_b16 v[34:35], v12 offset:256
  ds_read_b64_tr_b16 v[36:37], v12 offset:1024
  ds_read_b64_tr_b16 v[38:39], v12 offset:1280
  ds_read_b64_tr_b16 v[40:41], v12 offset:2048
  ds_read_b64_tr_b16 v[42:43], v12 offset:2304
  ds_read_b64_tr_b16 v[44:45], v12 offset:3072
  ds_read_b64_tr_b16 v[46:47], v12 offset:3328
  ds_read_b64_tr_b16 v[48:49], v12 offset:4096
  ds_read_b64_tr_b16 v[50:51], v12 offset:4352
LloopW:
  s_waitcnt lgkmcnt(0)
  v_mfma_f32_32x32x16_bf16 v[80:95], v[32:35], v[24:27], v[80:95]
  ds_read_b128 v[28:31], v9
  ds_read_b64_tr_b16 v[52:53], v12 offset:5120
  ds_read_b64_tr_b16 v[54:55], v12 offset:5376
  v_mfma_f32_32x32x16_bf16 v[96:111], v[36:39], v[24:27], v[96:111]
  ds_read_b64_tr_b16 v[56:57], v12 offset:6144
  ds_read_b64_tr_b16 v[58:59], v12 offset:6400
  ds_read_b64_tr_b16 v[60:61], v12 offset:7168
  v_mfma_f32_32x32x16_bf16 v[112:127], v[40:43], v[24:27], v[112:127]
  ds_read_b64_tr_b16 v[62:63], v12 offset:7424
  ds_read_b64_tr_b16 v[64:65], v12 offset:8192
  ds_read_b64_tr_b16 v[66:67], v12 offset:8448
  v_mfma_f32_32x32x16_bf16 v[128:143], v[44:47], v[24:27], v[128:143]
  ds_read_b64_tr_b16 v[68:69], v12 offset:9216
  ds_read_b64_tr_b16 v[70:71], v12 offset:9472
  v_mfma_f32_32x32x16_bf16 v[144:159], v[48:51], v[24:27], v[144:159]
  s_waitcnt lgkmcnt(0)
  v_mfma_f32_32x32x16_bf16 v[80:95], v[52:55], v[28:31], v[80:95]
  ds_read_b128 v[24:27], v10
  ds_read_b64_tr_b16 v[32:33], v12 offset:10240
  ds_read_b64_tr_b16 v[34:35], v12 offset:10496
  v_mfma_f32_32x32x16_bf16 v[96:111], v[56:59], v[28:31], v[96:111]
  ds_read_b64_tr_b16 v[36:37], v12 offset:11264
  ds_read_b64_tr_b16 v[38:39], v12 offset:11520
  ds_read_b64_tr_b16 v[40:41], v12 offset:12288
  v_mfma_f32_32x32x16_bf16 v[112:127], v[60:63], v[28:31], v[112:127]
  ds_read_b64_tr_b16 v[42:43], v12 offset:12544
  ds_read_b64_tr_b16 v[44:45], v12 offset:13312
  ds_read_b64_tr_b16 v[46:47], v12 offset:13568
  v_mfma_f32_32x32x16_bf16 v[128:143], v[64:67], v[28:31], v[128:143]
  ds_read_b64_tr_b16 v[48:49], v12 offset:14336
  ds_read_b64_tr_b16 v[50:51], v12 offset:14592
  v_mfma_f32_32x32x16_bf16 v[144:159], v[68:71], v[28:31], v[144:159]
  s_waitcnt lgkmcnt(0)
  v_mfma_f32_32x32x16_bf16 v[80:95], v[32:35], v[24:27], v[80:95]
  ds_read_b128 v[28:31], v11
  ds_read_b64_tr_b16 v[52:53], v12 offset:15360
  ds_read_b64_tr_b16 v[54:55], v12 offset:15616
  v_mfma_f32_32x32x16_bf16 v[96:111], v[36:39], v[24:27], v[96:111]
  ds_read_b64_tr_b16 v[56:57], v12 offset:16384
  ds_read_b64_tr_b16 v[58:59], v12 offset:16640
  ds_read_b64_tr_b16 v[60:61], v12 offset:17408
  v_mfma_f32_32x32x16_bf16 v[112:127], v[40:43], v[24:27], v[112:127]
  ds_read_b64_tr_b16 v[62:63], v12 offset:17664
  ds_read_b64_tr_b16 v[64:65], v12 offset:18432
  ds_read_b64_tr_b16 v[66:67], v12 offset:18688
  v_mfma_f32_32x32x16_bf16 v[128:143], v[44:47], v[24:27], v[128:143]
  ds_read_b64_tr_b16 v[68:69], v12 offset:19456
  ds_read_b64_tr_b16 v[70:71], v12 offset:19712
  v_mfma_f32_32x32x16_bf16 v[144:159], v[48:51], v[24:27], v[144:159]
  s_add_u32 s30, s30, 1
  s_and_b32 s28, s30, 3
  s_cselect_b32 s28, s38, s39
  v_add_u32 v8, s28, v8
  v_add_u32 v12, s28, v12
  s_waitcnt lgkmcnt(0)
  s_barrier
  v_mfma_f32_32x32x16_bf16 v[80:95], v[52:55], v[28:31], v[80:95]
  ds_read_b128 v[24:27], v8
  ds_read_b64_tr_b16 v[32:33], v12 offset:0
  ds_read_b64_tr_b16 v[34:35], v12 offset:256
  v_mfma_f32_32x32x16_bf16 v[96:111], v[56:59], v[28:31], v[96:111]
  ds_read_b64_tr_b16 v[36:37], v12 offset:1024
  ds_read_b64_tr_b16 v[38:39], v12 offset:1280
  ds_read_b64_tr_b16 v[40:41], v12 offset:2048
  v_mfma_f32_32x32x16_bf16 v[112:127], v[60:63], v[28:31], v[112:127]
  ds_read_b64_tr_b16 v[42:43], v12 offset:2304
  ds_read_b64_tr_b16 v[44:45], v12 offset:3072
  ds_read_b64_tr_b16 v[46:47], v12 offset:3328
  v_mfma_f32_32x32x16_bf16 v[128:143], v[64:67], v[28:31], v[128:143]
  ds_read_b64_tr_b16 v[48:49], v12 offset:4096
  ds_read_b64_tr_b16 v[50:51], v12 offset:4352
  v_add_u32 v9, s28, v9
  v_add_u32 v10, s28, v10
  v_add_u32 v11, s28, v11
  v_mfma_f32_32x32x16_bf16 v[144:159], v[68:71], v[28:31], v[144:159]
  s_cmp_lt_u32 s30, 7
  s_cbranch_scc1 LloopW
  s_waitcnt vmcnt(0)
  v_lshrrev_b32 v6, 5, v1
  v_and_b32 v5, 31, v1
  s_mul_i32 s29, s22, 384
  s_add_u32 s29, s29, 153216
  v_lshlrev_b32 v6, 5, v6
  v_add_u32 v6, 152576, v6
  v_lshlrev_b32 v7, 4, v1
  v_lshl_add_u32 v5, v5, 2, s29
  s_lshl_b32 s28, s20, 2
  s_add_u32 s28, s28, s22
  s_mul_i32 s28, s28, 112
  s_mul_i32 s30, s21, 10
  s_add_u32 s28, s28, s30
  s_lshl_b32 s28, s28, 10
  s_waitcnt lgkmcnt(0)
  s_barrier
  s_barrier
  ds_read_b32 v76, v5
  ds_read_b32 v72, v5 offset:256
  ds_read_b128 v[24:27], v6 offset:0
  ds_read_b128 v[28:31], v6 offset:16
  ds_read_b128 v[32:35], v6 offset:64
  ds_read_b128 v[36:39], v6 offset:80
  ds_read_b128 v[40:43], v6 offset:128
  ds_read_b128 v[44:47], v6 offset:144
  ds_read_b128 v[48:51], v6 offset:192
  ds_read_b128 v[52:55], v6 offset:208
  s_waitcnt lgkmcnt(4)
  v_pk_fma_f32 v[80:81], v[24:25], v[72:73], v[80:81] op_sel_hi:[1,0,1] neg_lo:[0,1,0] neg_hi:[0,1,0]
  v_pk_fma_f32 v[82:83], v[26:27], v[72:73], v[82:83] op_sel_hi:[1,0,1] neg_lo:[0,1,0] neg_hi:[0,1,0]
  v_pk_fma_f32 v[84:85], v[28:29], v[72:73], v[84:85] op_sel_hi:[1,0,1] neg_lo:[0,1,0] neg_hi:[0,1,0]
  v_pk_fma_f32 v[86:87], v[30:31], v[72:73], v[86:87] op_sel_hi:[1,0,1] neg_lo:[0,1,0] neg_hi:[0,1,0]
  v_pk_fma_f32 v[88:89], v[32:33], v[72:73], v[88:89] op_sel_hi:[1,0,1] neg_lo:[0,1,0] neg_hi:[0,1,0]
  v_pk_fma_f32 v[90:91], v[34:35], v[72:73], v[90:91] op_sel_hi:[1,0,1] neg_lo:[0,1,0] neg_hi:[0,1,0]
  v_pk_fma_f32 v[92:93], v[36:37], v[72:73], v[92:93] op_sel_hi:[1,0,1] neg_lo:[0,1,0] neg_hi:[0,1,0]
  v_pk_fma_f32 v[94:95], v[38:39], v[72:73], v[94:95] op_sel_hi:[1,0,1] neg_lo:[0,1,0] neg_hi:[0,1,0]
  v_pk_mul_f32 v[80:81], v[80:81], v[76:77] op_sel_hi:[1,0]
  v_pk_mul_f32 v[82:83], v[82:83], v[76:77] op_sel_hi:[1,0]
  v_pk_mul_f32 v[84:85], v[84:85], v[76:77] op_sel_hi:[1,0]
  v_pk_mul_f32 v[86:87], v[86:87], v[76:77] op_sel_hi:[1,0]
  v_pk_mul_f32 v[88:89], v[88:89], v[76:77] op_sel_hi:[1,0]
  v_pk_mul_f32 v[90:91], v[90:91], v[76:77] op_sel_hi:[1,0]
  v_pk_mul_f32 v[92:93], v[92:93], v[76:77] op_sel_hi:[1,0]
  v_pk_mul_f32 v[94:95], v[94:95], v[76:77] op_sel_hi:[1,0]
  v_cvt_pk_bf16_f32 v80, v80, v81
  v_cvt_pk_bf16_f32 v81, v82, v83
  v_cvt_pk_bf16_f32 v82, v84, v85
  v_cvt_pk_bf16_f32 v83, v86, v87
  v_cvt_pk_bf16_f32 v84, v88, v89
  v_cvt_pk_bf16_f32 v85, v90, v91
  v_cvt_pk_bf16_f32 v86, v92, v93
  v_cvt_pk_bf16_f32 v87, v94, v95
  v_pk_max_i16 v80, v80, 0
  v_pk_max_i16 v81, v81, 0
  v_pk_max_i16 v82, v82, 0
  v_pk_max_i16 v83, v83, 0
  v_pk_max_i16 v84, v84, 0
  v_pk_max_i16 v85, v85, 0
  v_pk_max_i16 v86, v86, 0
  v_pk_max_i16 v87, v87, 0
  buffer_store_dwordx4 v[80:83], v7, s[16:19], s28 offen offset:0 sc1
  buffer_store_dwordx4 v[84:87], v7, s[16:19], s28 offen offset:1024 sc1
  s_cmp_eq_u32 s21, 11
  s_cbranch_scc1 Lfin1
  ds_read_b128 v[24:27], v6 offset:256
  ds_read_b128 v[28:31], v6 offset:272
  ds_read_b128 v[32:35], v6 offset:320
  ds_read_b128 v[36:39], v6 offset:336
  s_waitcnt lgkmcnt(4)
  v_pk_fma_f32 v[96:97], v[40:41], v[72:73], v[96:97] op_sel_hi:[1,0,1] neg_lo:[0,1,0] neg_hi:[0,1,0]
  v_pk_fma_f32 v[98:99], v[42:43], v[72:73], v[98:99] op_sel_hi:[1,0,1] neg_lo:[0,1,0] neg_hi:[0,1,0]
  v_pk_fma_f32 v[100:101], v[44:45], v[72:73], v[100:101] op_sel_hi:[1,0,1] neg_lo:[0,1,0] neg_hi:[0,1,0]
  v_pk_fma_f32 v[102:103], v[46:47], v[72:73], v[102:103] op_sel_hi:[1,0,1] neg_lo:[0,1,0] neg_hi:[0,1,0]
  v_pk_fma_f32 v[104:105], v[48:49], v[72:73], v[104:105] op_sel_hi:[1,0,1] neg_lo:[0,1,0] neg_hi:[0,1,0]
  v_pk_fma_f32 v[106:107], v[50:51], v[72:73], v[106:107] op_sel_hi:[1,0,1] neg_lo:[0,1,0] neg_hi:[0,1,0]
  v_pk_fma_f32 v[108:109], v[52:53], v[72:73], v[108:109] op_sel_hi:[1,0,1] neg_lo:[0,1,0] neg_hi:[0,1,0]
  v_pk_fma_f32 v[110:111], v[54:55], v[72:73], v[110:111] op_sel_hi:[1,0,1] neg_lo:[0,1,0] neg_hi:[0,1,0]
  v_pk_mul_f32 v[96:97], v[96:97], v[76:77] op_sel_hi:[1,0]
  v_pk_mul_f32 v[98:99], v[98:99], v[76:77] op_sel_hi:[1,0]
  v_pk_mul_f32 v[100:101], v[100:101], v[76:77] op_sel_hi:[1,0]
  v_pk_mul_f32 v[102:103], v[102:103], v[76:77] op_sel_hi:[1,0]
  v_pk_mul_f32 v[104:105], v[104:105], v[76:77] op_sel_hi:[1,0]
  v_pk_mul_f32 v[106:107], v[106:107], v[76:77] op_sel_hi:[1,0]
  v_pk_mul_f32 v[108:109], v[108:109], v[76:77] op_sel_hi:[1,0]
  v_pk_mul_f32 v[110:111], v[110:111], v[76:77] op_sel_hi:[1,0]
  v_cvt_pk_bf16_f32 v96, v96, v97
  v_cvt_pk_bf16_f32 v97, v98, v99
  v_cvt_pk_bf16_f32 v98, v100, v101
  v_cvt_pk_bf16_f32 v99, v102, v103
  v_cvt_pk_bf16_f32 v100, v104, v105
  v_cvt_pk_bf16_f32 v101, v106, v107
  v_cvt_pk_bf16_f32 v102, v108, v109
  v_cvt_pk_bf16_f32 v103, v110, v111
  v_pk_max_i16 v96, v96, 0
  v_pk_max_i16 v97, v97, 0
  v_pk_max_i16 v98, v98, 0
  v_pk_max_i16 v99, v99, 0
  v_pk_max_i16 v100, v100, 0
  v_pk_max_i16 v101, v101, 0
  v_pk_max_i16 v102, v102, 0
  v_pk_max_i16 v103, v103, 0
  buffer_store_dwordx4 v[96:99], v7, s[16:19], s28 offen offset:2048 sc1
  buffer_store_dwordx4 v[100:103], v7, s[16:19], s28 offen offset:3072 sc1
  s_add_u32 s28, s28, 4096
  ds_read_b128 v[40:43], v6 offset:384
  ds_read_b128 v[44:47], v6 offset:400
  ds_read_b128 v[48:51], v6 offset:448
  ds_read_b128 v[52:55], v6 offset:464
  s_waitcnt lgkmcnt(4)
  v_pk_fma_f32 v[112:113], v[24:25], v[72:73], v[112:113] op_sel_hi:[1,0,1] neg_lo:[0,1,0] neg_hi:[0,1,0]
  v_pk_fma_f32 v[114:115], v[26:27], v[72:73], v[114:115] op_sel_hi:[1,0,1] neg_lo:[0,1,0] neg_hi:[0,1,0]
  v_pk_fma_f32 v[116:117], v[28:29], v[72:73], v[116:117] op_sel_hi:[1,0,1] neg_lo:[0,1,0] neg_hi:[0,1,0]
  v_pk_fma_f32 v[118:119], v[30:31], v[72:73], v[118:119] op_sel_hi:[1,0,1] neg_lo:[0,1,0] neg_hi:[0,1,0]
  v_pk_fma_f32 v[120:121], v[32:33], v[72:73], v[120:121] op_sel_hi:[1,0,1] neg_lo:[0,1,0] neg_hi:[0,1,0]
  v_pk_fma_f32 v[122:123], v[34:35], v[72:73], v[122:123] op_sel_hi:[1,0,1] neg_lo:[0,1,0] neg_hi:[0,1,0]
  v_pk_fma_f32 v[124:125], v[36:37], v[72:73], v[124:125] op_sel_hi:[1,0,1] neg_lo:[0,1,0] neg_hi:[0,1,0]
  v_pk_fma_f32 v[126:127], v[38:39], v[72:73], v[126:127] op_sel_hi:[1,0,1] neg_lo:[0,1,0] neg_hi:[0,1,0]
  v_pk_mul_f32 v[112:113], v[112:113], v[76:77] op_sel_hi:[1,0]
  v_pk_mul_f32 v[114:115], v[114:115], v[76:77] op_sel_hi:[1,0]
  v_pk_mul_f32 v[116:117], v[116:117], v[76:77] op_sel_hi:[1,0]
  v_pk_mul_f32 v[118:119], v[118:119], v[76:77] op_sel_hi:[1,0]
  v_pk_mul_f32 v[120:121], v[120:121], v[76:77] op_sel_hi:[1,0]
  v_pk_mul_f32 v[122:123], v[122:123], v[76:77] op_sel_hi:[1,0]
  v_pk_mul_f32 v[124:125], v[124:125], v[76:77] op_sel_hi:[1,0]
  v_pk_mul_f32 v[126:127], v[126:127], v[76:77] op_sel_hi:[1,0]
  v_cvt_pk_bf16_f32 v112, v112, v113
  v_cvt_pk_bf16_f32 v113, v114, v115
  v_cvt_pk_bf16_f32 v114, v116, v117
  v_cvt_pk_bf16_f32 v115, v118, v119
  v_cvt_pk_bf16_f32 v116, v120, v121
  v_cvt_pk_bf16_f32 v117, v122, v123
  v_cvt_pk_bf16_f32 v118, v124, v125
  v_cvt_pk_bf16_f32 v119, v126, v127
  v_pk_max_i16 v112, v112, 0
  v_pk_max_i16 v113, v113, 0
  v_pk_max_i16 v114, v114, 0
  v_pk_max_i16 v115, v115, 0
  v_pk_max_i16 v116, v116, 0
  v_pk_max_i16 v117, v117, 0
  v_pk_max_i16 v118, v118, 0
  v_pk_max_i16 v119, v119, 0
  buffer_store_dwordx4 v[112:115], v7, s[16:19], s28 offen offset:0 sc1
  buffer_store_dwordx4 v[116:119], v7, s[16:19], s28 offen offset:1024 sc1
  ds_read_b128 v[24:27], v6 offset:512
  ds_read_b128 v[28:31], v6 offset:528
  ds_read_b128 v[32:35], v6 offset:576
  ds_read_b128 v[36:39], v6 offset:592
  s_waitcnt lgkmcnt(4)
  v_pk_fma_f32 v[128:129], v[40:41], v[72:73], v[128:129] op_sel_hi:[1,0,1] neg_lo:[0,1,0] neg_hi:[0,1,0]
  v_pk_fma_f32 v[130:131], v[42:43], v[72:73], v[130:131] op_sel_hi:[1,0,1] neg_lo:[0,1,0] neg_hi:[0,1,0]
  v_pk_fma_f32 v[132:133], v[44:45], v[72:73], v[132:133] op_sel_hi:[1,0,1] neg_lo:[0,1,0] neg_hi:[0,1,0]
  v_pk_fma_f32 v[134:135], v[46:47], v[72:73], v[134:135] op_sel_hi:[1,0,1] neg_lo:[0,1,0] neg_hi:[0,1,0]
  v_pk_fma_f32 v[136:137], v[48:49], v[72:73], v[136:137] op_sel_hi:[1,0,1] neg_lo:[0,1,0] neg_hi:[0,1,0]
  v_pk_fma_f32 v[138:139], v[50:51], v[72:73], v[138:139] op_sel_hi:[1,0,1] neg_lo:[0,1,0] neg_hi:[0,1,0]
  v_pk_fma_f32 v[140:141], v[52:53], v[72:73], v[140:141] op_sel_hi:[1,0,1] neg_lo:[0,1,0] neg_hi:[0,1,0]
  v_pk_fma_f32 v[142:143], v[54:55], v[72:73], v[142:143] op_sel_hi:[1,0,1] neg_lo:[0,1,0] neg_hi:[0,1,0]
  v_pk_mul_f32 v[128:129], v[128:129], v[76:77] op_sel_hi:[1,0]
  v_pk_mul_f32 v[130:131], v[130:131], v[76:77] op_sel_hi:[1,0]
  v_pk_mul_f32 v[132:133], v[132:133], v[76:77] op_sel_hi:[1,0]
  v_pk_mul_f32 v[134:135], v[134:135], v[76:77] op_sel_hi:[1,0]
  v_pk_mul_f32 v[136:137], v[136:137], v[76:77] op_sel_hi:[1,0]
  v_pk_mul_f32 v[138:139], v[138:139], v[76:77] op_sel_hi:[1,0]
  v_pk_mul_f32 v[140:141], v[140:141], v[76:77] op_sel_hi:[1,0]
  v_pk_mul_f32 v[142:143], v[142:143], v[76:77] op_sel_hi:[1,0]
  v_cvt_pk_bf16_f32 v128, v128, v129
  v_cvt_pk_bf16_f32 v129, v130, v131
  v_cvt_pk_bf16_f32 v130, v132, v133
  v_cvt_pk_bf16_f32 v131, v134, v135
  v_cvt_pk_bf16_f32 v132, v136, v137
  v_cvt_pk_bf16_f32 v133, v138, v139
  v_cvt_pk_bf16_f32 v134, v140, v141
  v_cvt_pk_bf16_f32 v135, v142, v143
  v_pk_max_i16 v128, v128, 0
  v_pk_max_i16 v129, v129, 0
  v_pk_max_i16 v130, v130, 0
  v_pk_max_i16 v131, v131, 0
  v_pk_max_i16 v132, v132, 0
  v_pk_max_i16 v133, v133, 0
  v_pk_max_i16 v134, v134, 0
  v_pk_max_i16 v135, v135, 0
  buffer_store_dwordx4 v[128:131], v7, s[16:19], s28 offen offset:2048 sc1
  buffer_store_dwordx4 v[132:135], v7, s[16:19], s28 offen offset:3072 sc1
  s_add_u32 s28, s28, 4096
  s_waitcnt lgkmcnt(0)
  v_pk_fma_f32 v[144:145], v[24:25], v[72:73], v[144:145] op_sel_hi:[1,0,1] neg_lo:[0,1,0] neg_hi:[0,1,0]
  v_pk_fma_f32 v[146:147], v[26:27], v[72:73], v[146:147] op_sel_hi:[1,0,1] neg_lo:[0,1,0] neg_hi:[0,1,0]
  v_pk_fma_f32 v[148:149], v[28:29], v[72:73], v[148:149] op_sel_hi:[1,0,1] neg_lo:[0,1,0] neg_hi:[0,1,0]
  v_pk_fma_f32 v[150:151], v[30:31], v[72:73], v[150:151] op_sel_hi:[1,0,1] neg_lo:[0,1,0] neg_hi:[0,1,0]
  v_pk_fma_f32 v[152:153], v[32:33], v[72:73], v[152:153] op_sel_hi:[1,0,1] neg_lo:[0,1,0] neg_hi:[0,1,0]
  v_pk_fma_f32 v[154:155], v[34:35], v[72:73], v[154:155] op_sel_hi:[1,0,1] neg_lo:[0,1,0] neg_hi:[0,1,0]
  v_pk_fma_f32 v[156:157], v[36:37], v[72:73], v[156:157] op_sel_hi:[1,0,1] neg_lo:[0,1,0] neg_hi:[0,1,0]
  v_pk_fma_f32 v[158:159], v[38:39], v[72:73], v[158:159] op_sel_hi:[1,0,1] neg_lo:[0,1,0] neg_hi:[0,1,0]
  v_pk_mul_f32 v[144:145], v[144:145], v[76:77] op_sel_hi:[1,0]
  v_pk_mul_f32 v[146:147], v[146:147], v[76:77] op_sel_hi:[1,0]
  v_pk_mul_f32 v[148:149], v[148:149], v[76:77] op_sel_hi:[1,0]
  v_pk_mul_f32 v[150:151], v[150:151], v[76:77] op_sel_hi:[1,0]
  v_pk_mul_f32 v[152:153], v[152:153], v[76:77] op_sel_hi:[1,0]
  v_pk_mul_f32 v[154:155], v[154:155], v[76:77] op_sel_hi:[1,0]
  v_pk_mul_f32 v[156:157], v[156:157], v[76:77] op_sel_hi:[1,0]
  v_pk_mul_f32 v[158:159], v[158:159], v[76:77] op_sel_hi:[1,0]
  v_cvt_pk_bf16_f32 v144, v144, v145
  v_cvt_pk_bf16_f32 v145, v146, v147
  v_cvt_pk_bf16_f32 v146, v148, v149
  v_cvt_pk_bf16_f32 v147, v150, v151
  v_cvt_pk_bf16_f32 v148, v152, v153
  v_cvt_pk_bf16_f32 v149, v154, v155
  v_cvt_pk_bf16_f32 v150, v156, v157
  v_cvt_pk_bf16_f32 v151, v158, v159
  v_pk_max_i16 v144, v144, 0
  v_pk_max_i16 v145, v145, 0
  v_pk_max_i16 v146, v146, 0
  v_pk_max_i16 v147, v147, 0
  v_pk_max_i16 v148, v148, 0
  v_pk_max_i16 v149, v149, 0
  v_pk_max_i16 v150, v150, 0
  v_pk_max_i16 v151, v151, 0
  buffer_store_dwordx4 v[144:147], v7, s[16:19], s28 offen offset:0 sc1
  buffer_store_dwordx4 v[148:151], v7, s[16:19], s28 offen offset:1024 sc1
  s_branch Lfin1
LgF:
  s_getpc_b64 s[48:49]
LcpF:
  s_sub_u32 s48, s48, LcpF-k1_kernel
  s_subb_u32 s49, s49, 0
  s_mov_b32 s50, k2_kernel-k1_kernel
  s_mov_b32 s51, 0x20000
  s_lshl_b32 s33, s22, 13
  v_lshlrev_b32 v20, 7, v1
  buffer_load_dword v21, v20, s[48:51], s33 offen
  s_add_u32 s16, s6, 0x1400000
  s_addc_u32 s17, s7, 0
  s_mov_b32 s18, 0x1dc000
  s_mov_b32 s19, 0x20000
  s_lshl_b32 s28, s22, 12
  v_and_b32 v5, 31, v1
  v_lshrrev_b32 v6, 1, v5
  v_xor_b32 v6, v6, v5
  v_and_b32 v6, 4, v6
  v_mul_u32_u24 v6, 3, v6
  v_xor_b32 v5, v5, v6
  v_lshrrev_b32 v6, 5, v1
  v_bfe_u32 v7, v5, 1, 3
  v_lshlrev_b32 v5, 7, v5
  v_add_u32 v5, s28, v5
  v_add_u32 v17, 0, v6
  v_xor_b32 v17, v17, v7
  v_lshl_add_u32 v8, v17, 4, v5
  v_add_u32 v17, 2, v6
  v_xor_b32 v17, v17, v7
  v_lshl_add_u32 v9, v17, 4, v5
  v_add_u32 v17, 4, v6
  v_xor_b32 v17, v17, v7
  v_lshl_add_u32 v10, v17, 4, v5
  v_add_u32 v17, 6, v6
  v_xor_b32 v17, v17, v7
  v_lshl_add_u32 v11, v17, 4, v5
  v_lshrrev_b32 v12, 5, v1
  v_bfe_u32 v17, v1, 2, 2
  v_lshl_add_u32 v12, v12, 3, v17
  v_lshlrev_b32 v12, 6, v12
  v_bfe_u32 v17, v1, 4, 1
  v_and_b32 v18, 3, v1
  v_lshl_add_u32 v17, v17, 2, v18
  v_lshlrev_b32 v17, 2, v17
  v_lshl_add_u32 v12, v17, 1, v12
  v_add_u32 v12, 16384, v12
  v_mov_b32 v80, 0
  v_mov_b32 v81, 0
  v_mov_b32 v82, 0
  v_mov_b32 v83, 0
  v_mov_b32 v84, 0
  v_mov_b32 v85, 0
  v_mov_b32 v86, 0
  v_mov_b32 v87, 0
  v_mov_b32 v88, 0
  v_mov_b32 v89, 0
  v_mov_b32 v90, 0
  v_mov_b32 v91, 0
  v_mov_b32 v92, 0
  v_mov_b32 v93, 0
  v_mov_b32 v94, 0
  v_mov_b32 v95, 0
  v_mov_b32 v96, 0
  v_mov_b32 v97, 0
  v_mov_b32 v98, 0
  v_mov_b32 v99, 0
  v_mov_b32 v100, 0
  v_mov_b32 v101, 0
  v_mov_b32 v102, 0
  v_mov_b32 v103, 0
  v_mov_b32 v104, 0
  v_mov_b32 v105, 0
  v_mov_b32 v106, 0
  v_mov_b32 v107, 0
  v_mov_b32 v108, 0
  v_mov_b32 v109, 0
  v_mov_b32 v110, 0
  v_mov_b32 v111, 0
  v_mov_b32 v112, 0
  v_mov_b32 v113, 0
  v_mov_b32 v114, 0
  v_mov_b32 v115, 0
  v_mov_b32 v116, 0
  v_mov_b32 v117, 0
  v_mov_b32 v118, 0
  v_mov_b32 v119, 0
  v_mov_b32 v120, 0
  v_mov_b32 v121, 0
  v_mov_b32 v122, 0
  v_mov_b32 v123, 0
  v_mov_b32 v124, 0
  v_mov_b32 v125, 0
  v_mov_b32 v126, 0
  v_mov_b32 v127, 0
  v_mov_b32 v128, 0
  v_mov_b32 v129, 0
  v_mov_b32 v130, 0
  v_mov_b32 v131, 0
  v_mov_b32 v132, 0
  v_mov_b32 v133, 0
  v_mov_b32 v134, 0
  v_mov_b32 v135, 0
  v_mov_b32 v136, 0
  v_mov_b32 v137, 0
  v_mov_b32 v138, 0
  v_mov_b32 v139, 0
  v_mov_b32 v140, 0
  v_mov_b32 v141, 0
  v_mov_b32 v142, 0
  v_mov_b32 v143, 0
  v_mov_b32 v144, 0
  v_mov_b32 v145, 0
  v_mov_b32 v146, 0
  v_mov_b32 v147, 0
  v_mov_b32 v148, 0
  v_mov_b32 v149, 0
  v_mov_b32 v150, 0
  v_mov_b32 v151, 0
  v_mov_b32 v152, 0
  v_mov_b32 v153, 0
  v_mov_b32 v154, 0
  v_mov_b32 v155, 0
  v_mov_b32 v156, 0
  v_mov_b32 v157, 0
  v_mov_b32 v158, 0
  v_mov_b32 v159, 0
  s_mov_b32 s30, 0
  s_barrier
  ds_read_b128 v[24:27], v8
  ds_read_b64_tr_b16 v[32:33], v12 offset:0
  ds_read_b64_tr_b16 v[34:35], v12 offset:256
  ds_read_b64_tr_b16 v[36:37], v12 offset:1024
  ds_read_b64_tr_b16 v[38:39], v12 offset:1280
  ds_read_b64_tr_b16 v[40:41], v12 offset:2048
  ds_read_b64_tr_b16 v[42:43], v12 offset:2304
  ds_read_b64_tr_b16 v[44:45], v12 offset:3072
  ds_read_b64_tr_b16 v[46:47], v12 offset:3328
  ds_read_b64_tr_b16 v[48:49], v12 offset:4096
  ds_read_b64_tr_b16 v[50:51], v12 offset:4352
LloopF:
  s_waitcnt lgkmcnt(0)
  v_mfma_f32_32x32x16_bf16 v[80:95], v[24:27], v[32:35], v[80:95]
  ds_read_b128 v[28:31], v9
  ds_read_b64_tr_b16 v[52:53], v12 offset:5120
  ds_read_b64_tr_b16 v[54:55], v12 offset:5376
  v_mfma_f32_32x32x16_bf16 v[96:111], v[24:27], v[36:39], v[96:111]
  ds_read_b64_tr_b16 v[56:57], v12 offset:6144
  ds_read_b64_tr_b16 v[58:59], v12 offset:6400
  ds_read_b64_tr_b16 v[60:61], v12 offset:7168
  v_mfma_f32_32x32x16_bf16 v[112:127], v[24:27], v[40:43], v[112:127]
  ds_read_b64_tr_b16 v[62:63], v12 offset:7424
  ds_read_b64_tr_b16 v[64:65], v12 offset:8192
  ds_read_b64_tr_b16 v[66:67], v12 offset:8448
  v_mfma_f32_32x32x16_bf16 v[128:143], v[24:27], v[44:47], v[128:143]
  ds_read_b64_tr_b16 v[68:69], v12 offset:9216
  ds_read_b64_tr_b16 v[70:71], v12 offset:9472
  v_mfma_f32_32x32x16_bf16 v[144:159], v[24:27], v[48:51], v[144:159]
  s_waitcnt lgkmcnt(0)
  v_mfma_f32_32x32x16_bf16 v[80:95], v[28:31], v[52:55], v[80:95]
  ds_read_b128 v[24:27], v10
  ds_read_b64_tr_b16 v[32:33], v12 offset:10240
  ds_read_b64_tr_b16 v[34:35], v12 offset:10496
  v_mfma_f32_32x32x16_bf16 v[96:111], v[28:31], v[56:59], v[96:111]
  ds_read_b64_tr_b16 v[36:37], v12 offset:11264
  ds_read_b64_tr_b16 v[38:39], v12 offset:11520
  ds_read_b64_tr_b16 v[40:41], v12 offset:12288
  v_mfma_f32_32x32x16_bf16 v[112:127], v[28:31], v[60:63], v[112:127]
  ds_read_b64_tr_b16 v[42:43], v12 offset:12544
  ds_read_b64_tr_b16 v[44:45], v12 offset:13312
  ds_read_b64_tr_b16 v[46:47], v12 offset:13568
  v_mfma_f32_32x32x16_bf16 v[128:143], v[28:31], v[64:67], v[128:143]
  ds_read_b64_tr_b16 v[48:49], v12 offset:14336
  ds_read_b64_tr_b16 v[50:51], v12 offset:14592
  v_mfma_f32_32x32x16_bf16 v[144:159], v[28:31], v[68:71], v[144:159]
  s_waitcnt lgkmcnt(0)
  v_mfma_f32_32x32x16_bf16 v[80:95], v[24:27], v[32:35], v[80:95]
  ds_read_b128 v[28:31], v11
  ds_read_b64_tr_b16 v[52:53], v12 offset:15360
  ds_read_b64_tr_b16 v[54:55], v12 offset:15616
  v_mfma_f32_32x32x16_bf16 v[96:111], v[24:27], v[36:39], v[96:111]
  ds_read_b64_tr_b16 v[56:57], v12 offset:16384
  ds_read_b64_tr_b16 v[58:59], v12 offset:16640
  ds_read_b64_tr_b16 v[60:61], v12 offset:17408
  v_mfma_f32_32x32x16_bf16 v[112:127], v[24:27], v[40:43], v[112:127]
  ds_read_b64_tr_b16 v[62:63], v12 offset:17664
  ds_read_b64_tr_b16 v[64:65], v12 offset:18432
  ds_read_b64_tr_b16 v[66:67], v12 offset:18688
  v_mfma_f32_32x32x16_bf16 v[128:143], v[24:27], v[44:47], v[128:143]
  ds_read_b64_tr_b16 v[68:69], v12 offset:19456
  ds_read_b64_tr_b16 v[70:71], v12 offset:19712
  v_mfma_f32_32x32x16_bf16 v[144:159], v[24:27], v[48:51], v[144:159]
  s_add_u32 s30, s30, 1
  s_and_b32 s28, s30, 3
  s_cselect_b32 s28, s38, s39
  v_add_u32 v8, s28, v8
  v_add_u32 v12, s28, v12
  s_waitcnt lgkmcnt(0)
  s_barrier
  v_mfma_f32_32x32x16_bf16 v[80:95], v[28:31], v[52:55], v[80:95]
  ds_read_b128 v[24:27], v8
  ds_read_b64_tr_b16 v[32:33], v12 offset:0
  ds_read_b64_tr_b16 v[34:35], v12 offset:256
  v_mfma_f32_32x32x16_bf16 v[96:111], v[28:31], v[56:59], v[96:111]
  ds_read_b64_tr_b16 v[36:37], v12 offset:1024
  ds_read_b64_tr_b16 v[38:39], v12 offset:1280
  ds_read_b64_tr_b16 v[40:41], v12 offset:2048
  v_mfma_f32_32x32x16_bf16 v[112:127], v[28:31], v[60:63], v[112:127]
  ds_read_b64_tr_b16 v[42:43], v12 offset:2304
  ds_read_b64_tr_b16 v[44:45], v12 offset:3072
  ds_read_b64_tr_b16 v[46:47], v12 offset:3328
  v_mfma_f32_32x32x16_bf16 v[128:143], v[28:31], v[64:67], v[128:143]
  ds_read_b64_tr_b16 v[48:49], v12 offset:4096
  ds_read_b64_tr_b16 v[50:51], v12 offset:4352
  v_add_u32 v9, s28, v9
  v_add_u32 v10, s28, v10
  v_add_u32 v11, s28, v11
  v_mfma_f32_32x32x16_bf16 v[144:159], v[28:31], v[68:71], v[144:159]
  s_cmp_lt_u32 s30, 7
  s_cbranch_scc1 LloopF
  s_waitcnt vmcnt(0)
  v_lshrrev_b32 v6, 5, v1
  v_and_b32 v5, 31, v1
  s_mul_i32 s29, s22, 384
  s_add_u32 s29, s29, 153216
  v_lshl_add_u32 v4, v6, 5, s29
  v_lshlrev_b32 v3, 2, v5
  v_add_u32 v3, 152576, v3
  v_mul_u32_u24 v7, 272, v5
  v_lshl_add_u32 v7, v6, 4, v7
  s_lshl_b32 s30, s22, 6
  v_add_u32 v7, s30, v7
  v_lshrrev_b32 v8, 4, v1
  v_and_b32 v9, 15, v1
  v_lshlrev_b32 v9, 4, v9
  v_mul_u32_u24 v10, 4352, v8
  v_add_u32 v10, v10, v9
  v_mul_u32_u24 v8, 272, v8
  s_mul_i32 s30, s22, 10880
  v_add3_u32 v8, v8, v9, s30
  s_mul_i32 s28, s21, 696320
  s_lshl_b32 s30, s20, 8
  s_add_u32 s28, s28, s30
  s_mul_i32 s30, s22, 174080
  s_add_u32 s28, s28, s30
  s_waitcnt lgkmcnt(0)
  s_barrier
  ds_read_b128 v[24:27], v4 offset:0
  ds_read_b128 v[28:31], v4 offset:16
  ds_read_b128 v[32:35], v4 offset:64
  ds_read_b128 v[36:39], v4 offset:80
  ds_read_b128 v[40:43], v4 offset:128
  ds_read_b128 v[44:47], v4 offset:144
  ds_read_b128 v[48:51], v4 offset:192
  ds_read_b128 v[52:55], v4 offset:208
  ds_read_b32 v60, v3 offset:0
  ds_read_b32 v62, v3 offset:128
  ds_read_b32 v64, v3 offset:256
  ds_read_b32 v66, v3 offset:384
  ds_read_b32 v68, v3 offset:512
  s_waitcnt lgkmcnt(0)
  v_pk_mul_f32 v[80:81], v[80:81], v[24:25]
  v_pk_mul_f32 v[82:83], v[82:83], v[26:27]
  v_pk_mul_f32 v[84:85], v[84:85], v[28:29]
  v_pk_mul_f32 v[86:87], v[86:87], v[30:31]
  v_pk_mul_f32 v[88:89], v[88:89], v[32:33]
  v_pk_mul_f32 v[90:91], v[90:91], v[34:35]
  v_pk_mul_f32 v[92:93], v[92:93], v[36:37]
  v_pk_mul_f32 v[94:95], v[94:95], v[38:39]
  v_pk_fma_f32 v[80:81], v[40:41], v[60:61], v[80:81] op_sel_hi:[1,0,1] neg_lo:[0,1,0] neg_hi:[0,1,0]
  v_pk_fma_f32 v[82:83], v[42:43], v[60:61], v[82:83] op_sel_hi:[1,0,1] neg_lo:[0,1,0] neg_hi:[0,1,0]
  v_pk_fma_f32 v[84:85], v[44:45], v[60:61], v[84:85] op_sel_hi:[1,0,1] neg_lo:[0,1,0] neg_hi:[0,1,0]
  v_pk_fma_f32 v[86:87], v[46:47], v[60:61], v[86:87] op_sel_hi:[1,0,1] neg_lo:[0,1,0] neg_hi:[0,1,0]
  v_pk_fma_f32 v[88:89], v[48:49], v[60:61], v[88:89] op_sel_hi:[1,0,1] neg_lo:[0,1,0] neg_hi:[0,1,0]
  v_pk_fma_f32 v[90:91], v[50:51], v[60:61], v[90:91] op_sel_hi:[1,0,1] neg_lo:[0,1,0] neg_hi:[0,1,0]
  v_pk_fma_f32 v[92:93], v[52:53], v[60:61], v[92:93] op_sel_hi:[1,0,1] neg_lo:[0,1,0] neg_hi:[0,1,0]
  v_pk_fma_f32 v[94:95], v[54:55], v[60:61], v[94:95] op_sel_hi:[1,0,1] neg_lo:[0,1,0] neg_hi:[0,1,0]
  v_cvt_pk_bf16_f32 v80, v80, v81
  v_cvt_pk_bf16_f32 v81, v82, v83
  v_cvt_pk_bf16_f32 v82, v84, v85
  v_cvt_pk_bf16_f32 v83, v86, v87
  v_cvt_pk_bf16_f32 v84, v88, v89
  v_cvt_pk_bf16_f32 v85, v90, v91
  v_cvt_pk_bf16_f32 v86, v92, v93
  v_cvt_pk_bf16_f32 v87, v94, v95
  ds_write_b128 v7, v[80:83] offset:0
  ds_write_b128 v7, v[84:87] offset:32
  v_pk_mul_f32 v[96:97], v[96:97], v[24:25]
  v_pk_mul_f32 v[98:99], v[98:99], v[26:27]
  v_pk_mul_f32 v[100:101], v[100:101], v[28:29]
  v_pk_mul_f32 v[102:103], v[102:103], v[30:31]
  v_pk_mul_f32 v[104:105], v[104:105], v[32:33]
  v_pk_mul_f32 v[106:107], v[106:107], v[34:35]
  v_pk_mul_f32 v[108:109], v[108:109], v[36:37]
  v_pk_mul_f32 v[110:111], v[110:111], v[38:39]
  v_pk_fma_f32 v[96:97], v[40:41], v[62:63], v[96:97] op_sel_hi:[1,0,1] neg_lo:[0,1,0] neg_hi:[0,1,0]
  v_pk_fma_f32 v[98:99], v[42:43], v[62:63], v[98:99] op_sel_hi:[1,0,1] neg_lo:[0,1,0] neg_hi:[0,1,0]
  v_pk_fma_f32 v[100:101], v[44:45], v[62:63], v[100:101] op_sel_hi:[1,0,1] neg_lo:[0,1,0] neg_hi:[0,1,0]
  v_pk_fma_f32 v[102:103], v[46:47], v[62:63], v[102:103] op_sel_hi:[1,0,1] neg_lo:[0,1,0] neg_hi:[0,1,0]
  v_pk_fma_f32 v[104:105], v[48:49], v[62:63], v[104:105] op_sel_hi:[1,0,1] neg_lo:[0,1,0] neg_hi:[0,1,0]
  v_pk_fma_f32 v[106:107], v[50:51], v[62:63], v[106:107] op_sel_hi:[1,0,1] neg_lo:[0,1,0] neg_hi:[0,1,0]
  v_pk_fma_f32 v[108:109], v[52:53], v[62:63], v[108:109] op_sel_hi:[1,0,1] neg_lo:[0,1,0] neg_hi:[0,1,0]
  v_pk_fma_f32 v[110:111], v[54:55], v[62:63], v[110:111] op_sel_hi:[1,0,1] neg_lo:[0,1,0] neg_hi:[0,1,0]
  v_cvt_pk_bf16_f32 v96, v96, v97
  v_cvt_pk_bf16_f32 v97, v98, v99
  v_cvt_pk_bf16_f32 v98, v100, v101
  v_cvt_pk_bf16_f32 v99, v102, v103
  v_cvt_pk_bf16_f32 v100, v104, v105
  v_cvt_pk_bf16_f32 v101, v106, v107
  v_cvt_pk_bf16_f32 v102, v108, v109
  v_cvt_pk_bf16_f32 v103, v110, v111
  ds_write_b128 v7, v[96:99] offset:8704
  ds_write_b128 v7, v[100:103] offset:8736
  v_pk_mul_f32 v[112:113], v[112:113], v[24:25]
  v_pk_mul_f32 v[114:115], v[114:115], v[26:27]
  v_pk_mul_f32 v[116:117], v[116:117], v[28:29]
  v_pk_mul_f32 v[118:119], v[118:119], v[30:31]
  v_pk_mul_f32 v[120:121], v[120:121], v[32:33]
  v_pk_mul_f32 v[122:123], v[122:123], v[34:35]
  v_pk_mul_f32 v[124:125], v[124:125], v[36:37]
  v_pk_mul_f32 v[126:127], v[126:127], v[38:39]
  v_pk_fma_f32 v[112:113], v[40:41], v[64:65], v[112:113] op_sel_hi:[1,0,1] neg_lo:[0,1,0] neg_hi:[0,1,0]
  v_pk_fma_f32 v[114:115], v[42:43], v[64:65], v[114:115] op_sel_hi:[1,0,1] neg_lo:[0,1,0] neg_hi:[0,1,0]
  v_pk_fma_f32 v[116:117], v[44:45], v[64:65], v[116:117] op_sel_hi:[1,0,1] neg_lo:[0,1,0] neg_hi:[0,1,0]
  v_pk_fma_f32 v[118:119], v[46:47], v[64:65], v[118:119] op_sel_hi:[1,0,1] neg_lo:[0,1,0] neg_hi:[0,1,0]
  v_pk_fma_f32 v[120:121], v[48:49], v[64:65], v[120:121] op_sel_hi:[1,0,1] neg_lo:[0,1,0] neg_hi:[0,1,0]
  v_pk_fma_f32 v[122:123], v[50:51], v[64:65], v[122:123] op_sel_hi:[1,0,1] neg_lo:[0,1,0] neg_hi:[0,1,0]
  v_pk_fma_f32 v[124:125], v[52:53], v[64:65], v[124:125] op_sel_hi:[1,0,1] neg_lo:[0,1,0] neg_hi:[0,1,0]
  v_pk_fma_f32 v[126:127], v[54:55], v[64:65], v[126:127] op_sel_hi:[1,0,1] neg_lo:[0,1,0] neg_hi:[0,1,0]
  v_cvt_pk_bf16_f32 v112, v112, v113
  v_cvt_pk_bf16_f32 v113, v114, v115
  v_cvt_pk_bf16_f32 v114, v116, v117
  v_cvt_pk_bf16_f32 v115, v118, v119
  v_cvt_pk_bf16_f32 v116, v120, v121
  v_cvt_pk_bf16_f32 v117, v122, v123
  v_cvt_pk_bf16_f32 v118, v124, v125
  v_cvt_pk_bf16_f32 v119, v126, v127
  ds_write_b128 v7, v[112:115] offset:17408
  ds_write_b128 v7, v[116:119] offset:17440
  v_pk_mul_f32 v[128:129], v[128:129], v[24:25]
  v_pk_mul_f32 v[130:131], v[130:131], v[26:27]
  v_pk_mul_f32 v[132:133], v[132:133], v[28:29]
  v_pk_mul_f32 v[134:135], v[134:135], v[30:31]
  v_pk_mul_f32 v[136:137], v[136:137], v[32:33]
  v_pk_mul_f32 v[138:139], v[138:139], v[34:35]
  v_pk_mul_f32 v[140:141], v[140:141], v[36:37]
  v_pk_mul_f32 v[142:143], v[142:143], v[38:39]
  v_pk_fma_f32 v[128:129], v[40:41], v[66:67], v[128:129] op_sel_hi:[1,0,1] neg_lo:[0,1,0] neg_hi:[0,1,0]
  v_pk_fma_f32 v[130:131], v[42:43], v[66:67], v[130:131] op_sel_hi:[1,0,1] neg_lo:[0,1,0] neg_hi:[0,1,0]
  v_pk_fma_f32 v[132:133], v[44:45], v[66:67], v[132:133] op_sel_hi:[1,0,1] neg_lo:[0,1,0] neg_hi:[0,1,0]
  v_pk_fma_f32 v[134:135], v[46:47], v[66:67], v[134:135] op_sel_hi:[1,0,1] neg_lo:[0,1,0] neg_hi:[0,1,0]
  v_pk_fma_f32 v[136:137], v[48:49], v[66:67], v[136:137] op_sel_hi:[1,0,1] neg_lo:[0,1,0] neg_hi:[0,1,0]
  v_pk_fma_f32 v[138:139], v[50:51], v[66:67], v[138:139] op_sel_hi:[1,0,1] neg_lo:[0,1,0] neg_hi:[0,1,0]
  v_pk_fma_f32 v[140:141], v[52:53], v[66:67], v[140:141] op_sel_hi:[1,0,1] neg_lo:[0,1,0] neg_hi:[0,1,0]
  v_pk_fma_f32 v[142:143], v[54:55], v[66:67], v[142:143] op_sel_hi:[1,0,1] neg_lo:[0,1,0] neg_hi:[0,1,0]
  v_cvt_pk_bf16_f32 v128, v128, v129
  v_cvt_pk_bf16_f32 v129, v130, v131
  v_cvt_pk_bf16_f32 v130, v132, v133
  v_cvt_pk_bf16_f32 v131, v134, v135
  v_cvt_pk_bf16_f32 v132, v136, v137
  v_cvt_pk_bf16_f32 v133, v138, v139
  v_cvt_pk_bf16_f32 v134, v140, v141
  v_cvt_pk_bf16_f32 v135, v142, v143
  ds_write_b128 v7, v[128:131] offset:26112
  ds_write_b128 v7, v[132:135] offset:26144
  v_pk_mul_f32 v[144:145], v[144:145], v[24:25]
  v_pk_mul_f32 v[146:147], v[146:147], v[26:27]
  v_pk_mul_f32 v[148:149], v[148:149], v[28:29]
  v_pk_mul_f32 v[150:151], v[150:151], v[30:31]
  v_pk_mul_f32 v[152:153], v[152:153], v[32:33]
  v_pk_mul_f32 v[154:155], v[154:155], v[34:35]
  v_pk_mul_f32 v[156:157], v[156:157], v[36:37]
  v_pk_mul_f32 v[158:159], v[158:159], v[38:39]
  v_pk_fma_f32 v[144:145], v[40:41], v[68:69], v[144:145] op_sel_hi:[1,0,1] neg_lo:[0,1,0] neg_hi:[0,1,0]
  v_pk_fma_f32 v[146:147], v[42:43], v[68:69], v[146:147] op_sel_hi:[1,0,1] neg_lo:[0,1,0] neg_hi:[0,1,0]
  v_pk_fma_f32 v[148:149], v[44:45], v[68:69], v[148:149] op_sel_hi:[1,0,1] neg_lo:[0,1,0] neg_hi:[0,1,0]
  v_pk_fma_f32 v[150:151], v[46:47], v[68:69], v[150:151] op_sel_hi:[1,0,1] neg_lo:[0,1,0] neg_hi:[0,1,0]
  v_pk_fma_f32 v[152:153], v[48:49], v[68:69], v[152:153] op_sel_hi:[1,0,1] neg_lo:[0,1,0] neg_hi:[0,1,0]
  v_pk_fma_f32 v[154:155], v[50:51], v[68:69], v[154:155] op_sel_hi:[1,0,1] neg_lo:[0,1,0] neg_hi:[0,1,0]
  v_pk_fma_f32 v[156:157], v[52:53], v[68:69], v[156:157] op_sel_hi:[1,0,1] neg_lo:[0,1,0] neg_hi:[0,1,0]
  v_pk_fma_f32 v[158:159], v[54:55], v[68:69], v[158:159] op_sel_hi:[1,0,1] neg_lo:[0,1,0] neg_hi:[0,1,0]
  v_cvt_pk_bf16_f32 v144, v144, v145
  v_cvt_pk_bf16_f32 v145, v146, v147
  v_cvt_pk_bf16_f32 v146, v148, v149
  v_cvt_pk_bf16_f32 v147, v150, v151
  v_cvt_pk_bf16_f32 v148, v152, v153
  v_cvt_pk_bf16_f32 v149, v154, v155
  v_cvt_pk_bf16_f32 v150, v156, v157
  v_cvt_pk_bf16_f32 v151, v158, v159
  ds_write_b128 v7, v[144:147] offset:34816
  ds_write_b128 v7, v[148:151] offset:34848
  s_waitcnt lgkmcnt(0)
  s_barrier
  ds_read_b128 v[80:83], v8 offset:0
  ds_read_b128 v[84:87], v8 offset:1088
  ds_read_b128 v[88:91], v8 offset:2176
  ds_read_b128 v[92:95], v8 offset:3264
  ds_read_b128 v[96:99], v8 offset:4352
  ds_read_b128 v[100:103], v8 offset:5440
  ds_read_b128 v[104:107], v8 offset:6528
  ds_read_b128 v[108:111], v8 offset:7616
  ds_read_b128 v[112:115], v8 offset:8704
  ds_read_b128 v[116:119], v8 offset:9792
  s_waitcnt lgkmcnt(9)
  buffer_store_dwordx4 v[80:83], v10, s[16:19], s28 offen sc1
  s_add_u32 s28, s28, 17408
  s_waitcnt lgkmcnt(8)
  buffer_store_dwordx4 v[84:87], v10, s[16:19], s28 offen sc1
  s_add_u32 s28, s28, 17408
  s_waitcnt lgkmcnt(7)
  buffer_store_dwordx4 v[88:91], v10, s[16:19], s28 offen sc1
  s_add_u32 s28, s28, 17408
  s_waitcnt lgkmcnt(6)
  buffer_store_dwordx4 v[92:95], v10, s[16:19], s28 offen sc1
  s_add_u32 s28, s28, 17408
  s_waitcnt lgkmcnt(5)
  buffer_store_dwordx4 v[96:99], v10, s[16:19], s28 offen sc1
  s_add_u32 s28, s28, 17408
  s_waitcnt lgkmcnt(4)
  buffer_store_dwordx4 v[100:103], v10, s[16:19], s28 offen sc1
  s_add_u32 s28, s28, 17408
  s_waitcnt lgkmcnt(3)
  buffer_store_dwordx4 v[104:107], v10, s[16:19], s28 offen sc1
  s_add_u32 s28, s28, 17408
  s_waitcnt lgkmcnt(2)
  buffer_store_dwordx4 v[108:111], v10, s[16:19], s28 offen sc1
  s_add_u32 s28, s28, 17408
  s_waitcnt lgkmcnt(1)
  buffer_store_dwordx4 v[112:115], v10, s[16:19], s28 offen sc1
  s_add_u32 s28, s28, 17408
  s_waitcnt lgkmcnt(0)
  buffer_store_dwordx4 v[116:119], v10, s[16:19], s28 offen sc1
  s_add_u32 s28, s28, 17408
  s_branch Lfin1
Lwt:
  s_load_dwordx4 s[24:27], s[0:1], 8
  s_waitcnt lgkmcnt(0)
  s_mov_b32 s8, s24
  s_mov_b32 s9, s25
  s_mov_b32 s10, 0xe1000
  s_mov_b32 s11, 0x20000
  s_mov_b32 s12, s26
  s_mov_b32 s13, s27
  s_mov_b32 s14, 0xe1000
  s_mov_b32 s15, 0x20000
  s_add_u32 s16, s6, 0x8c0000
  s_addc_u32 s17, s7, 0
  s_mov_b32 s18, 0x1c2000
  s_mov_b32 s19, 0x20000
  s_lshr_b32 s24, s20, 2
  s_and_b32 s25, s20, 3
  v_lshlrev_b32 v2, 4, v1
  s_cmp_ge_u32 s3, 8
  s_cbranch_scc0 Lwt1
  s_load_dwordx2 s[44:45], s[0:1], 40
  s_mov_b32 s46, 1605632
  s_mov_b32 s47, 0x20000
  s_lshr_b32 s28, s2, 3
  s_lshl_b32 s28, s28, 2
  s_add_u32 s28, s28, s22
  s_and_b32 s33, s28, 3
  s_mul_i32 s28, s28, 6272
  s_bitcmp1_b32 s2, 2
  s_cselect_b32 s29, 802816, 0
  s_add_u32 s28, s28, s29
  v_lshlrev_b32 v40, 7, v1
  s_getpc_b64 s[48:49]
Lpfw:
  s_add_u32 s48, s48, k2_kernel-Lpfw
  s_addc_u32 s49, s49, 0
  s_mov_b32 s50, ftab-k2_kernel
  s_mov_b32 s51, 0x20000
  s_lshl_b32 s33, s33, 13
  buffer_load_dword v42, v40, s[48:51], s33 offen
  v_cmp_gt_u32 vcc, 49, v1
  s_and_saveexec_b64 s[52:53], vcc
  s_waitcnt lgkmcnt(0)
  buffer_load_dword v41, v40, s[44:47], s28 offen
  s_mov_b64 exec, s[52:53]
  s_branch Lwt2
Lwt1:
  s_lshr_b32 s28, s3, 2
  s_lshl_b32 s28, s28, 4
  s_and_b32 s29, s3, 3
  s_add_u32 s28, s28, s29
  s_lshl_b32 s29, s25, 2
  s_add_u32 s28, s28, s29
  s_lshl_b32 s28, s28, 2
  s_add_u32 s28, s28, s24
  s_mul_i32 s28, s28, 7200
  s_lshl_b32 s30, s3, 13
  s_add_u32 s29, s28, 4096
  s_add_u32 m0, s30, 0
  s_nop 0
  buffer_load_dwordx4 v2, s[8:11], s28 offen offset:0 lds
  buffer_load_dwordx4 v2, s[8:11], s28 offen offset:1024 lds
  buffer_load_dwordx4 v2, s[8:11], s28 offen offset:2048 lds
  buffer_load_dwordx4 v2, s[8:11], s28 offen offset:3072 lds
  s_add_u32 m0, s30, 4096
  s_nop 0
  buffer_load_dwordx4 v2, s[8:11], s29 offen offset:0 lds
  buffer_load_dwordx4 v2, s[8:11], s29 offen offset:1024 lds
  buffer_load_dwordx4 v2, s[8:11], s29 offen offset:2048 lds
  buffer_load_dwordx4 v2, s[8:11], s29 offen offset:3072 lds
  s_add_u32 m0, s30, 65536
  s_nop 0
  buffer_load_dwordx4 v2, s[12:15], s28 offen offset:0 lds
  buffer_load_dwordx4 v2, s[12:15], s28 offen offset:1024 lds
  buffer_load_dwordx4 v2, s[12:15], s28 offen offset:2048 lds
  buffer_load_dwordx4 v2, s[12:15], s28 offen offset:3072 lds
  s_add_u32 m0, s30, 69632
  s_nop 0
  buffer_load_dwordx4 v2, s[12:15], s29 offen offset:0 lds
  buffer_load_dwordx4 v2, s[12:15], s29 offen offset:1024 lds
  buffer_load_dwordx4 v2, s[12:15], s29 offen offset:2048 lds
  buffer_load_dwordx4 v2, s[12:15], s29 offen offset:3072 lds
Lwt2:
  v_and_b32 v3, 15, v1
  v_lshrrev_b32 v4, 4, v1
  s_lshl_b32 s28, s3, 2
  v_add_u32 v4, s28, v4
  v_lshrrev_b32 v5, 1, v3
  v_mul_u32_u24 v5, 450, v5
  v_lshl_add_u32 v5, v4, 1, v5
  v_and_b32 v6, 1, v1
  v_lshl_add_u32 v5, v6, 15, v5
  v_add_u32 v6, 65536, v5
  v_lshlrev_b32 v7, 13, v4
  v_lshl_add_u32 v7, v3, 4, v7
  s_lshl_b32 s29, s24, 2
  s_add_u32 s29, s29, s25
  s_lshl_b32 s29, s29, 9
  s_mov_b32 s30, 0
  s_waitcnt vmcnt(0)
  s_barrier
Lwt3:
  ds_read_u16 v16, v5 offset:0
  ds_read_u16 v24, v6 offset:0
  ds_read_u16 v17, v5 offset:8192
  ds_read_u16 v25, v6 offset:8192
  ds_read_u16 v18, v5 offset:16384
  ds_read_u16 v26, v6 offset:16384
  ds_read_u16 v19, v5 offset:24576
  ds_read_u16 v27, v6 offset:24576
  ds_read_u16 v20, v5 offset:3600
  ds_read_u16 v28, v6 offset:3600
  ds_read_u16 v21, v5 offset:11792
  ds_read_u16 v29, v6 offset:11792
  ds_read_u16 v22, v5 offset:19984
  ds_read_u16 v30, v6 offset:19984
  ds_read_u16 v23, v5 offset:28176
  ds_read_u16 v31, v6 offset:28176
  v_add_u32 v5, 96, v5
  v_add_u32 v6, 96, v6
  s_add_u32 s30, s30, 1
  s_waitcnt lgkmcnt(0)
  v_lshl_or_b32 v8, v24, 16, v16
  v_lshl_or_b32 v9, v25, 16, v17
  v_lshl_or_b32 v10, v26, 16, v18
  v_lshl_or_b32 v11, v27, 16, v19
  v_lshl_or_b32 v12, v28, 16, v20
  v_lshl_or_b32 v13, v29, 16, v21
  v_lshl_or_b32 v14, v30, 16, v22
  v_lshl_or_b32 v15, v31, 16, v23
  buffer_store_dwordx4 v[8:11], v7, s[16:19], s29 offen
  buffer_store_dwordx4 v[12:15], v7, s[16:19], s29 offen offset:256
  s_add_u32 s29, s29, 393216
  s_cmp_lt_u32 s30, 5
  s_cbranch_scc1 Lwt3
Lfin1:
Lend1:
  s_endpgm
.globl k2_kernel
.p2align 8
.type k2_kernel,@function
k2_kernel:
  s_cmp_ge_u32 s2, 256
  s_cbranch_scc1 Lend2
  s_load_dwordx2 s[4:5], s[0:1], 40
  s_load_dwordx2 s[6:7], s[0:1], 64
  v_lshrrev_b32 v2, 6, v0
  v_and_b32 v1, 63, v0
  v_and_b32 v0, 255, v0
  v_readfirstlane_b32 s3, v2
  s_bfe_u32 s20, s2, 0x10002
  s_lshl_b32 s20, s20, 1
  s_bfe_u32 s28, s2, 0x10005
  s_add_u32 s20, s20, s28
  s_lshr_b32 s21, s2, 6
  s_and_b32 s28, s2, 3
  s_lshl_b32 s28, s28, 2
  s_bfe_u32 s29, s2, 0x20003
  s_add_u32 s28, s28, s29
  s_lshl_b32 s23, s28, 2
  s_mul_i32 s30, s21, 7
  s_add_u32 s30, s30, 1
  s_lshr_b32 s30, s30, 1
  s_and_b32 s22, s3, 3
  s_cmp_lt_u32 s3, 4
  s_waitcnt lgkmcnt(0)
  s_cbranch_scc1 Lg2
  s_cmp_lt_u32 s3, 8
  s_cbranch_scc1 Ll2
  s_cmp_ge_u32 s2, 225
  s_cbranch_scc1 Lend2
  s_add_u32 s16, s6, 0xb00000
  s_addc_u32 s17, s7, 0
  s_mov_b32 s18, 0x1dc000
  s_mov_b32 s19, 0x20000
  s_mul_i32 s24, s2, 8704
  s_add_u32 s25, s24, 4352
  s_mov_b32 s26, 0x36124925
  s_cmp_eq_u32 s2, 224
  s_cselect_b32 s24, 4352, s24
  s_cselect_b32 s27, 0, s2
  s_cmp_eq_u32 s27, 0
  s_cselect_b32 s25, 0x40000000, s25
  s_cselect_b32 s26, 0x35924925, s26
  v_and_b32 v2, 15, v1
  v_lshrrev_b32 v3, 4, v1
  v_lshlrev_b32 v4, 7, v2
  v_and_b32 v5, 7, v1
  v_xor_b32 v5, v5, v3
  v_lshl_add_u32 v5, v5, 4, v4
  v_add_u32 v5, 140288, v5
  v_lshlrev_b32 v40, 5, v0
  v_add_u32 v40, 148480, v40
  v_xor_b32 v41, 64, v5
  v_cvt_f32_u32 v152, v2
  v_cvt_f32_u32 v153, v3
  s_lshl_b32 s28, s22, 4
  v_cvt_f32_u32 v155, s28
  v_add_f32 v154, v152, v155
  s_mov_b32 s29, 0x80008000
  s_brev_b32 s30, 1
  v_and_b32 v148, 1, v1
  v_mul_lo_u32 v148, v148, s29
  v_mul_f32 v156, 0x3c800000, v154
  v_mul_f32 v157, 0x41000000, v153
  v_mul_f32 v158, v156, v157
  v_mul_f32 v159, 4.0, v156
  v_cos_f32 v160, v158
  v_sin_f32 v164, v158
  v_add_f32 v158, v158, v156
  v_cos_f32 v161, v158
  v_sin_f32 v165, v158
  v_add_f32 v158, v158, v156
  v_cos_f32 v162, v158
  v_sin_f32 v166, v158
  v_add_f32 v158, v158, v156
  v_cos_f32 v163, v158
  v_sin_f32 v167, v158
  v_cos_f32 v144, v159
  v_sin_f32 v146, v159
  s_nop 0
  v_pk_mul_f32 v[128:129], v[160:161], v[144:145] op_sel_hi:[1,0]
  v_pk_mul_f32 v[132:133], v[164:165], v[144:145] op_sel_hi:[1,0]
  v_pk_mul_f32 v[130:131], v[162:163], v[144:145] op_sel_hi:[1,0]
  v_pk_mul_f32 v[134:135], v[166:167], v[144:145] op_sel_hi:[1,0]
  v_pk_fma_f32 v[128:129], v[164:165], v[146:147], v[128:129] op_sel_hi:[1,0,1] neg_lo:[1,0,0] neg_hi:[1,0,0]
  v_pk_fma_f32 v[132:133], v[160:161], v[146:147], v[132:133] op_sel_hi:[1,0,1]
  v_pk_fma_f32 v[130:131], v[166:167], v[146:147], v[130:131] op_sel_hi:[1,0,1] neg_lo:[1,0,0] neg_hi:[1,0,0]
  v_pk_fma_f32 v[134:135], v[162:163], v[146:147], v[134:135] op_sel_hi:[1,0,1]
  v_cvt_pk_bf16_f32 v48, v160, v161
  v_cvt_pk_bf16_f32 v56, v164, v165
  v_cvt_pk_bf16_f32 v50, v128, v129
  v_cvt_pk_bf16_f32 v58, v132, v133
  v_cvt_pk_bf16_f32 v49, v162, v163
  v_cvt_pk_bf16_f32 v57, v166, v167
  v_cvt_pk_bf16_f32 v51, v130, v131
  v_cvt_pk_bf16_f32 v59, v134, v135
  v_xor_b32 v52, v148, v48
  v_xor_b32 v60, v148, v56
  v_xor_b32 v53, v148, v49
  v_xor_b32 v61, v148, v57
  v_xor_b32 v54, v148, v50
  v_xor_b32 v62, v148, v58
  v_xor_b32 v55, v148, v51
  v_xor_b32 v63, v148, v59
  v_xor_b32 v64, s29, v56
  v_xor_b32 v65, s29, v57
  v_xor_b32 v66, s29, v58
  v_xor_b32 v67, s29, v59
  v_xor_b32 v68, s29, v60
  v_xor_b32 v69, s29, v61
  v_xor_b32 v70, s29, v62
  v_xor_b32 v71, s29, v63
  v_mul_f32 v157, 4.0, v153
  v_mul_f32 v156, 0x3a000000, v154
  v_mul_f32 v158, v156, v157
  v_mul_f32 v159, 0x41800000, v156
  v_cos_f32 v96, v158
  v_sin_f32 v104, v158
  v_add_f32 v158, v158, v156
  v_cos_f32 v97, v158
  v_sin_f32 v105, v158
  v_add_f32 v158, v158, v156
  v_cos_f32 v98, v158
  v_sin_f32 v106, v158
  v_add_f32 v158, v158, v156
  v_cos_f32 v99, v158
  v_sin_f32 v107, v158
  v_cos_f32 v144, v159
  v_sin_f32 v146, v159
  s_nop 0
  v_pk_mul_f32 v[100:101], v[96:97], v[144:145] op_sel_hi:[1,0]
  v_pk_mul_f32 v[108:109], v[104:105], v[144:145] op_sel_hi:[1,0]
  v_pk_mul_f32 v[102:103], v[98:99], v[144:145] op_sel_hi:[1,0]
  v_pk_mul_f32 v[110:111], v[106:107], v[144:145] op_sel_hi:[1,0]
  v_pk_fma_f32 v[100:101], v[104:105], v[146:147], v[100:101] op_sel_hi:[1,0,1] neg_lo:[1,0,0] neg_hi:[1,0,0]
  v_pk_fma_f32 v[108:109], v[96:97], v[146:147], v[108:109] op_sel_hi:[1,0,1]
  v_pk_fma_f32 v[102:103], v[106:107], v[146:147], v[102:103] op_sel_hi:[1,0,1] neg_lo:[1,0,0] neg_hi:[1,0,0]
  v_pk_fma_f32 v[110:111], v[98:99], v[146:147], v[110:111] op_sel_hi:[1,0,1]
  v_mul_f32 v156, 0x3d000000, v152
  v_mul_f32 v158, v156, v157
  v_cos_f32 v160, v158
  v_sin_f32 v164, v158
  v_add_f32 v158, v158, v156
  v_cos_f32 v161, v158
  v_sin_f32 v165, v158
  v_add_f32 v158, v158, v156
  v_cos_f32 v162, v158
  v_sin_f32 v166, v158
  v_add_f32 v158, v158, v156
  v_cos_f32 v163, v158
  v_sin_f32 v167, v158
  s_nop 0
  v_cvt_pk_bf16_f32 v72, v160, v161
  v_cvt_pk_bf16_f32 v80, v164, v165
  v_cvt_pk_bf16_f32 v73, v162, v163
  v_cvt_pk_bf16_f32 v81, v166, v167
  v_xor_b32 v74, v148, v72
  v_xor_b32 v82, v148, v80
  v_xor_b32 v88, s29, v80
  v_xor_b32 v75, v148, v73
  v_xor_b32 v83, v148, v81
  v_xor_b32 v89, s29, v81
  v_xor_b32 v90, s29, v82
  v_xor_b32 v91, s29, v83
  v_xor_b32 v76, s30, v72
  v_xor_b32 v84, s30, v80
  v_xor_b32 v92, s30, v88
  v_xor_b32 v77, s30, v73
  v_xor_b32 v85, s30, v81
  v_xor_b32 v93, s30, v89
  v_xor_b32 v78, s30, v74
  v_xor_b32 v86, s30, v82
  v_xor_b32 v94, s30, v90
  v_xor_b32 v79, s30, v75
  v_xor_b32 v87, s30, v83
  v_xor_b32 v95, s30, v91
  s_barrier
  v_add_f32 v157, v157, v155
  v_mul_f32 v156, 0x3a000000, v152
  v_mul_f32 v158, v156, v157
  v_cos_f32 v112, v158
  v_sin_f32 v120, v158
  v_add_f32 v158, v158, v156
  v_cos_f32 v113, v158
  v_sin_f32 v121, v158
  v_add_f32 v158, v158, v156
  v_cos_f32 v114, v158
  v_sin_f32 v122, v158
  v_add_f32 v158, v158, v156
  v_cos_f32 v115, v158
  v_sin_f32 v123, v158
  s_nop 0
  v_pk_mul_f32 v[112:113], v[112:113], s[26:27] op_sel_hi:[1,0]
  v_pk_mul_f32 v[114:115], v[114:115], s[26:27] op_sel_hi:[1,0]
  v_pk_mul_f32 v[120:121], v[120:121], s[26:27] op_sel_hi:[1,0]
  v_pk_mul_f32 v[122:123], v[122:123], s[26:27] op_sel_hi:[1,0]
  v_add_f32 v156, 0x3c000000, v156
  v_mul_f32 v158, v156, v157
  v_cos_f32 v116, v158
  v_sin_f32 v124, v158
  v_add_f32 v158, v158, v156
  v_cos_f32 v117, v158
  v_sin_f32 v125, v158
  v_add_f32 v158, v158, v156
  v_cos_f32 v118, v158
  v_sin_f32 v126, v158
  v_add_f32 v158, v158, v156
  v_cos_f32 v119, v158
  v_sin_f32 v127, v158
  s_nop 0
  v_pk_mul_f32 v[116:117], v[116:117], s[26:27] op_sel_hi:[1,0]
  v_pk_mul_f32 v[118:119], v[118:119], s[26:27] op_sel_hi:[1,0]
  v_pk_mul_f32 v[124:125], v[124:125], s[26:27] op_sel_hi:[1,0]
  v_pk_mul_f32 v[126:127], v[126:127], s[26:27] op_sel_hi:[1,0]
  v_mul_u32_u24 v7, 144, v2
  v_add_u32 v7, 131072, v7
  s_lshl_b32 s28, s22, 5
  v_lshl_add_u32 v6, v3, 3, v7
  v_add_u32 v6, s28, v6
  v_lshl_add_u32 v7, v3, 4, v7
  v_add_u32 v4, 9216, v6
  s_barrier
  ds_read_b128 v[8:11], v5 offset:0
  ds_read_b128 v[24:27], v5 offset:4096
  ds_read_b128 v[16:19], v5 offset:2048
  ds_read_b128 v[32:35], v5 offset:6144
  ds_read_b128 v[12:15], v41 offset:0
  ds_read_b128 v[28:31], v41 offset:4096
  ds_read_b128 v[20:23], v41 offset:2048
  ds_read_b128 v[36:39], v41 offset:6144
  ds_read_b128 v[44:47], v40 offset:16
  ds_read_b128 v[40:43], v40
  s_waitcnt lgkmcnt(2)
  s_cmp_lt_u32 s25, 0x40000000
  s_cbranch_scc1 Lhasim
  v_mov_b32 v24, 0
  v_mov_b32 v25, 0
  v_mov_b32 v26, 0
  v_mov_b32 v27, 0
  v_mov_b32 v28, 0
  v_mov_b32 v29, 0
  v_mov_b32 v30, 0
  v_mov_b32 v31, 0
  v_mov_b32 v32, 0
  v_mov_b32 v33, 0
  v_mov_b32 v34, 0
  v_mov_b32 v35, 0
  v_mov_b32 v36, 0
  v_mov_b32 v37, 0
  v_mov_b32 v38, 0
  v_mov_b32 v39, 0
  s_nop 1
Lhasim:
  v_mfma_f32_16x16x32_bf16 v[128:131], v[8:11], v[48:51], 0
  v_mfma_f32_16x16x32_bf16 v[136:139], v[24:27], v[48:51], 0
  v_mfma_f32_16x16x32_bf16 v[132:135], v[16:19], v[48:51], 0
  v_mfma_f32_16x16x32_bf16 v[140:143], v[32:35], v[48:51], 0
  v_mfma_f32_16x16x32_bf16 v[128:131], v[24:27], v[56:59], v[128:131]
  v_mfma_f32_16x16x32_bf16 v[136:139], v[8:11], v[64:67], v[136:139]
  v_mfma_f32_16x16x32_bf16 v[132:135], v[32:35], v[56:59], v[132:135]
  v_mfma_f32_16x16x32_bf16 v[140:143], v[16:19], v[64:67], v[140:143]
  v_mfma_f32_16x16x32_bf16 v[128:131], v[12:15], v[52:55], v[128:131]
  v_mfma_f32_16x16x32_bf16 v[136:139], v[28:31], v[52:55], v[136:139]
  v_mfma_f32_16x16x32_bf16 v[132:135], v[20:23], v[52:55], v[132:135]
  v_mfma_f32_16x16x32_bf16 v[140:143], v[36:39], v[52:55], v[140:143]
  v_mfma_f32_16x16x32_bf16 v[128:131], v[28:31], v[60:63], v[128:131]
  v_mfma_f32_16x16x32_bf16 v[136:139], v[12:15], v[68:71], v[136:139]
  v_mfma_f32_16x16x32_bf16 v[132:135], v[36:39], v[60:63], v[132:135]
  v_mfma_f32_16x16x32_bf16 v[140:143], v[20:23], v[68:71], v[140:143]
  s_nop 6
  v_pk_mul_f32 v[152:153], v[128:129], v[96:97]
  v_pk_mul_f32 v[160:161], v[136:137], v[96:97]
  v_pk_mul_f32 v[154:155], v[130:131], v[98:99]
  v_pk_mul_f32 v[162:163], v[138:139], v[98:99]
  v_pk_mul_f32 v[156:157], v[132:133], v[100:101]
  v_pk_mul_f32 v[164:165], v[140:141], v[100:101]
  v_pk_mul_f32 v[158:159], v[134:135], v[102:103]
  v_pk_mul_f32 v[166:167], v[142:143], v[102:103]
  v_pk_fma_f32 v[152:153], v[136:137], v[104:105], v[152:153]
  v_pk_fma_f32 v[160:161], v[128:129], v[104:105], v[160:161] neg_lo:[1,0,0] neg_hi:[1,0,0]
  v_pk_fma_f32 v[154:155], v[138:139], v[106:107], v[154:155]
  v_pk_fma_f32 v[162:163], v[130:131], v[106:107], v[162:163] neg_lo:[1,0,0] neg_hi:[1,0,0]
  v_pk_fma_f32 v[156:157], v[140:141], v[108:109], v[156:157]
  v_pk_fma_f32 v[164:165], v[132:133], v[108:109], v[164:165] neg_lo:[1,0,0] neg_hi:[1,0,0]
  v_pk_fma_f32 v[158:159], v[142:143], v[110:111], v[158:159]
  v_pk_fma_f32 v[166:167], v[134:135], v[110:111], v[166:167] neg_lo:[1,0,0] neg_hi:[1,0,0]
  v_cvt_pk_bf16_f32 v144, v152, v153
  v_cvt_pk_bf16_f32 v148, v160, v161
  v_cvt_pk_bf16_f32 v145, v154, v155
  v_cvt_pk_bf16_f32 v149, v162, v163
  v_cvt_pk_bf16_f32 v146, v156, v157
  v_cvt_pk_bf16_f32 v150, v164, v165
  v_cvt_pk_bf16_f32 v147, v158, v159
  v_cvt_pk_bf16_f32 v151, v166, v167
  s_nop 1
  v_mfma_f32_16x16x32_bf16 v[128:131], v[72:75], v[144:147], 0
  v_mfma_f32_16x16x32_bf16 v[136:139], v[72:75], v[148:151], 0
  v_mfma_f32_16x16x32_bf16 v[132:135], v[76:79], v[144:147], 0
  v_mfma_f32_16x16x32_bf16 v[140:143], v[76:79], v[148:151], 0
  v_mfma_f32_16x16x32_bf16 v[128:131], v[80:83], v[148:151], v[128:131]
  v_mfma_f32_16x16x32_bf16 v[136:139], v[88:91], v[144:147], v[136:139]
  v_mfma_f32_16x16x32_bf16 v[132:135], v[84:87], v[148:151], v[132:135]
  v_mfma_f32_16x16x32_bf16 v[140:143], v[92:95], v[144:147], v[140:143]
  s_waitcnt lgkmcnt(0)
  s_barrier
  v_lshlrev_b32 v8, 16, v40
  v_and_b32 v16, 0xffff0000, v40
  v_lshlrev_b32 v9, 16, v41
  v_and_b32 v17, 0xffff0000, v41
  v_lshlrev_b32 v10, 16, v42
  v_and_b32 v18, 0xffff0000, v42
  v_lshlrev_b32 v11, 16, v43
  v_and_b32 v19, 0xffff0000, v43
  v_lshlrev_b32 v12, 16, v44
  v_and_b32 v20, 0xffff0000, v44
  v_lshlrev_b32 v13, 16, v45
  v_and_b32 v21, 0xffff0000, v45
  v_lshlrev_b32 v14, 16, v46
  v_and_b32 v22, 0xffff0000, v46
  v_lshlrev_b32 v15, 16, v47
  v_and_b32 v23, 0xffff0000, v47
  s_nop 6
  v_pk_mul_f32 v[152:153], v[128:129], v[8:9]
  v_pk_mul_f32 v[160:161], v[136:137], v[8:9]
  v_pk_mul_f32 v[154:155], v[130:131], v[10:11]
  v_pk_mul_f32 v[162:163], v[138:139], v[10:11]
  v_pk_mul_f32 v[156:157], v[132:133], v[12:13]
  v_pk_mul_f32 v[164:165], v[140:141], v[12:13]
  v_pk_mul_f32 v[158:159], v[134:135], v[14:15]
  v_pk_mul_f32 v[166:167], v[142:143], v[14:15]
  v_pk_fma_f32 v[152:153], v[136:137], v[16:17], v[152:153] neg_lo:[1,0,0] neg_hi:[1,0,0]
  v_pk_fma_f32 v[160:161], v[128:129], v[16:17], v[160:161]
  v_pk_fma_f32 v[154:155], v[138:139], v[18:19], v[154:155] neg_lo:[1,0,0] neg_hi:[1,0,0]
  v_pk_fma_f32 v[162:163], v[130:131], v[18:19], v[162:163]
  v_pk_fma_f32 v[156:157], v[140:141], v[20:21], v[156:157] neg_lo:[1,0,0] neg_hi:[1,0,0]
  v_pk_fma_f32 v[164:165], v[132:133], v[20:21], v[164:165]
  v_pk_fma_f32 v[158:159], v[142:143], v[22:23], v[158:159] neg_lo:[1,0,0] neg_hi:[1,0,0]
  v_pk_fma_f32 v[166:167], v[134:135], v[22:23], v[166:167]
  v_cvt_pk_bf16_f32 v144, v152, v153
  v_cvt_pk_bf16_f32 v148, v160, v161
  v_cvt_pk_bf16_f32 v145, v154, v155
  v_cvt_pk_bf16_f32 v149, v162, v163
  v_cvt_pk_bf16_f32 v146, v156, v157
  v_cvt_pk_bf16_f32 v150, v164, v165
  v_cvt_pk_bf16_f32 v147, v158, v159
  v_cvt_pk_bf16_f32 v151, v166, v167
  s_nop 1
  v_mfma_f32_16x16x32_bf16 v[128:131], v[144:147], v[72:75], 0
  v_mfma_f32_16x16x32_bf16 v[136:139], v[148:151], v[72:75], 0
  v_mfma_f32_16x16x32_bf16 v[132:135], v[144:147], v[76:79], 0
  v_mfma_f32_16x16x32_bf16 v[140:143], v[148:151], v[76:79], 0
  v_mfma_f32_16x16x32_bf16 v[128:131], v[148:151], v[88:91], v[128:131]
  v_mfma_f32_16x16x32_bf16 v[136:139], v[144:147], v[80:83], v[136:139]
  v_mfma_f32_16x16x32_bf16 v[132:135], v[148:151], v[92:95], v[132:135]
  v_mfma_f32_16x16x32_bf16 v[140:143], v[144:147], v[84:87], v[140:143]
  s_nop 6
  v_pk_mul_f32 v[152:153], v[128:129], v[112:113]
  v_pk_mul_f32 v[160:161], v[136:137], v[112:113]
  v_pk_mul_f32 v[154:155], v[130:131], v[114:115]
  v_pk_mul_f32 v[162:163], v[138:139], v[114:115]
  v_pk_mul_f32 v[156:157], v[132:133], v[116:117]
  v_pk_mul_f32 v[164:165], v[140:141], v[116:117]
  v_pk_mul_f32 v[158:159], v[134:135], v[118:119]
  v_pk_mul_f32 v[166:167], v[142:143], v[118:119]
  v_pk_fma_f32 v[152:153], v[136:137], v[120:121], v[152:153] neg_lo:[1,0,0] neg_hi:[1,0,0]
  v_pk_fma_f32 v[160:161], v[128:129], v[120:121], v[160:161]
  v_pk_fma_f32 v[154:155], v[138:139], v[122:123], v[154:155] neg_lo:[1,0,0] neg_hi:[1,0,0]
  v_pk_fma_f32 v[162:163], v[130:131], v[122:123], v[162:163]
  v_pk_fma_f32 v[156:157], v[140:141], v[124:125], v[156:157] neg_lo:[1,0,0] neg_hi:[1,0,0]
  v_pk_fma_f32 v[164:165], v[132:133], v[124:125], v[164:165]
  v_pk_fma_f32 v[158:159], v[142:143], v[126:127], v[158:159] neg_lo:[1,0,0] neg_hi:[1,0,0]
  v_pk_fma_f32 v[166:167], v[134:135], v[126:127], v[166:167]
  v_cvt_pk_bf16_f32 v144, v152, v153
  v_cvt_pk_bf16_f32 v148, v160, v161
  v_cvt_pk_bf16_f32 v145, v154, v155
  v_cvt_pk_bf16_f32 v149, v162, v163
  v_cvt_pk_bf16_f32 v146, v156, v157
  v_cvt_pk_bf16_f32 v150, v164, v165
  v_cvt_pk_bf16_f32 v147, v158, v159
  v_cvt_pk_bf16_f32 v151, v166, v167
  s_nop 1
  ds_write_b64 v6, v[144:145] offset:0
  ds_write_b64 v6, v[148:149] offset:4608
  ds_write_b64 v6, v[146:147] offset:2304
  ds_write_b64 v6, v[150:151] offset:6912
  s_waitcnt lgkmcnt(0)
  s_barrier
  ds_read_b128 v[8:11], v7 offset:0
  ds_read_b128 v[24:27], v7 offset:4608
  ds_read_b128 v[16:19], v7 offset:2304
  ds_read_b128 v[32:35], v7 offset:6912
  ds_read_b128 v[12:15], v7 offset:64
  ds_read_b128 v[28:31], v7 offset:4672
  ds_read_b128 v[20:23], v7 offset:2368
  ds_read_b128 v[36:39], v7 offset:6976
  s_waitcnt lgkmcnt(4)
  v_mfma_f32_16x16x32_bf16 v[128:131], v[48:51], v[8:11], 0
  v_mfma_f32_16x16x32_bf16 v[136:139], v[48:51], v[24:27], 0
  v_mfma_f32_16x16x32_bf16 v[132:135], v[48:51], v[16:19], 0
  v_mfma_f32_16x16x32_bf16 v[140:143], v[48:51], v[32:35], 0
  v_mfma_f32_16x16x32_bf16 v[128:131], v[64:67], v[24:27], v[128:131]
  v_mfma_f32_16x16x32_bf16 v[136:139], v[56:59], v[8:11], v[136:139]
  v_mfma_f32_16x16x32_bf16 v[132:135], v[64:67], v[32:35], v[132:135]
  v_mfma_f32_16x16x32_bf16 v[140:143], v[56:59], v[16:19], v[140:143]
  s_waitcnt lgkmcnt(0)
  v_mfma_f32_16x16x32_bf16 v[128:131], v[52:55], v[12:15], v[128:131]
  v_mfma_f32_16x16x32_bf16 v[136:139], v[52:55], v[28:31], v[136:139]
  v_mfma_f32_16x16x32_bf16 v[132:135], v[52:55], v[20:23], v[132:135]
  v_mfma_f32_16x16x32_bf16 v[140:143], v[52:55], v[36:39], v[140:143]
  v_mfma_f32_16x16x32_bf16 v[128:131], v[68:71], v[28:31], v[128:131]
  v_mfma_f32_16x16x32_bf16 v[136:139], v[60:63], v[12:15], v[136:139]
  v_mfma_f32_16x16x32_bf16 v[132:135], v[68:71], v[36:39], v[132:135]
  v_mfma_f32_16x16x32_bf16 v[140:143], v[60:63], v[20:23], v[140:143]
  s_nop 6
  v_cvt_pk_bf16_f32 v144, v128, v129
  v_cvt_pk_bf16_f32 v148, v136, v137
  v_cvt_pk_bf16_f32 v145, v130, v131
  v_cvt_pk_bf16_f32 v149, v138, v139
  v_cvt_pk_bf16_f32 v146, v132, v133
  v_cvt_pk_bf16_f32 v150, v140, v141
  v_cvt_pk_bf16_f32 v147, v134, v135
  v_cvt_pk_bf16_f32 v151, v142, v143
  ds_write_b64 v4, v[144:145] offset:0
  ds_write_b64 v4, v[148:149] offset:4608
  ds_write_b64 v4, v[146:147] offset:2304
  ds_write_b64 v4, v[150:151] offset:6912
  v_lshrrev_b32 v5, 3, v1
  v_mul_u32_u24 v5, 144, v5
  v_and_b32 v6, 7, v1
  v_lshl_add_u32 v5, v6, 4, v5
  s_mul_i32 s28, s22, 1152
  s_add_u32 s28, s28, 140288
  v_add_u32 v5, s28, v5
  v_lshlrev_b32 v6, 4, v0
  s_waitcnt lgkmcnt(0)
  s_barrier
  ds_read_b128 v[8:11], v5
  ds_read_b128 v[12:15], v5 offset:4608
  s_waitcnt lgkmcnt(1)
  buffer_store_dwordx4 v[8:11], v6, s[16:19], s24 offen sc1
  s_waitcnt lgkmcnt(0)
  buffer_store_dwordx4 v[12:15], v6, s[16:19], s25 offen sc1
  s_barrier
  s_barrier
  s_branch Lfin2
Ll2:
  s_mov_b32 s8, s6
  s_mov_b32 s9, s7
  s_mov_b32 s10, 0x700000
  s_mov_b32 s11, 0x20000
  s_mov_b32 s12, s4
  s_mov_b32 s13, s5
  s_mov_b32 s14, 0x188000
  s_mov_b32 s15, 0x20000
  s_add_u32 s24, s23, s22
  s_mul_i32 s24, s24, 112
  s_mul_i32 s28, s20, 28
  s_add_u32 s24, s24, s28
  s_lshl_b32 s24, s24, 10
  s_mul_i32 s25, s20, 448
  s_lshl_b32 s28, s22, 4
  s_add_u32 s25, s25, s28
  s_mul_i32 s25, s25, 896
  s_lshl_b32 s28, s30, 6
  s_add_u32 s25, s25, s28
  s_add_u32 s27, s25, 192
  s_bitcmp1_b32 s21, 0
  s_cselect_b32 s27, 0x40000000, s27
  s_lshl_b32 s26, s22, 12
  v_lshlrev_b32 v2, 4, v1
  v_lshrrev_b32 v4, 2, v1
  v_mul_u32_u24 v4, 896, v4
  v_and_b32 v5, 3, v1
  v_lshl_add_u32 v4, v5, 4, v4
  s_setprio 3
  s_add_u32 m0, s26, 0
  s_add_u32 s28, s24, 0
  buffer_load_dwordx4 v2, s[8:11], s28 offen offset:0 lds
  buffer_load_dwordx4 v2, s[8:11], s28 offen offset:1024 lds
  buffer_load_dwordx4 v2, s[8:11], s28 offen offset:2048 lds
  buffer_load_dwordx4 v2, s[8:11], s28 offen offset:3072 lds
  s_add_u32 m0, s26, 16384
  s_add_u32 s28, s25, 0
  buffer_load_dwordx4 v4, s[12:15], s28 offen lds
  s_add_u32 m0, s26, 17408
  s_add_u32 s28, s25, 64
  buffer_load_dwordx4 v4, s[12:15], s28 offen lds
  s_add_u32 m0, s26, 18432
  s_add_u32 s28, s25, 128
  buffer_load_dwordx4 v4, s[12:15], s28 offen lds
  s_add_u32 m0, s26, 19456
  s_add_u32 s28, s27, 0
  buffer_load_dwordx4 v4, s[12:15], s28 offen lds
  s_cmp_ge_u32 s2, 225
  s_cbranch_scc1 Lnox
  s_mov_b32 s36, s24
  s_mov_b32 s37, s25
  s_mov_b32 s38, s26
  s_mov_b32 s39, s27
  s_mul_i32 s24, s2, 8704
  s_add_u32 s25, s24, 4352
  s_mov_b32 s26, 0x36124925
  s_cmp_eq_u32 s2, 224
  s_cselect_b32 s24, 4352, s24
  s_cselect_b32 s27, 0, s2
  s_cmp_eq_u32 s27, 0
  s_cselect_b32 s25, 0x40000000, s25
  s_cselect_b32 s26, 0x35924925, s26
  s_add_u32 s16, s6, 0x1400000
  s_addc_u32 s17, s7, 0
  s_mov_b32 s18, 0x1dc000
  s_mov_b32 s19, 0x20000
  s_add_u32 s40, s6, 0x8c0000
  s_addc_u32 s41, s7, 0
  s_mov_b32 s42, 0x1c2000
  s_mov_b32 s43, 0x20000
  v_lshrrev_b32 v6, 3, v1
  v_xor_b32 v6, v6, v1
  v_and_b32 v6, 7, v6
  v_and_b32 v7, 56, v1
  v_add_u32 v6, v6, v7
  v_lshlrev_b32 v6, 4, v6
  s_lshl_b32 s28, s22, 10
  s_add_u32 m0, s28, 140288
  s_add_u32 s24, s24, s28
  buffer_load_dwordx4 v6, s[16:19], s24 offen lds
  s_add_u32 m0, s28, 144384
  s_add_u32 s25, s25, s28
  buffer_load_dwordx4 v6, s[16:19], s25 offen lds
  s_lshl_b32 s28, s22, 11
  s_add_u32 m0, s28, 148480
  s_lshl_b32 s29, s2, 13
  s_add_u32 s28, s28, s29
  buffer_load_dwordx4 v2, s[40:43], s28 offen lds
  buffer_load_dwordx4 v2, s[40:43], s28 offen offset:1024 lds
  s_mov_b32 s24, s36
  s_mov_b32 s25, s37
  s_mov_b32 s26, s38
  s_mov_b32 s27, s39
  s_add_u32 m0, s26, 32768
  s_add_u32 s28, s24, 4096
  buffer_load_dwordx4 v2, s[8:11], s28 offen offset:0 lds
  buffer_load_dwordx4 v2, s[8:11], s28 offen offset:1024 lds
  buffer_load_dwordx4 v2, s[8:11], s28 offen offset:2048 lds
  buffer_load_dwordx4 v2, s[8:11], s28 offen offset:3072 lds
  s_add_u32 m0, s26, 49152
  s_add_u32 s28, s25, 57344
  buffer_load_dwordx4 v4, s[12:15], s28 offen lds
  s_add_u32 m0, s26, 50176
  s_add_u32 s28, s25, 57408
  buffer_load_dwordx4 v4, s[12:15], s28 offen lds
  s_add_u32 m0, s26, 51200
  s_add_u32 s28, s25, 57472
  buffer_load_dwordx4 v4, s[12:15], s28 offen lds
  s_add_u32 m0, s26, 52224
  s_add_u32 s28, s27, 57344
  buffer_load_dwordx4 v4, s[12:15], s28 offen lds
  s_waitcnt vmcnt(12)
  s_branch Lxd
Lnox:
  s_add_u32 m0, s26, 32768
  s_add_u32 s28, s24, 4096
  buffer_load_dwordx4 v2, s[8:11], s28 offen offset:0 lds
  buffer_load_dwordx4 v2, s[8:11], s28 offen offset:1024 lds
  buffer_load_dwordx4 v2, s[8:11], s28 offen offset:2048 lds
  buffer_load_dwordx4 v2, s[8:11], s28 offen offset:3072 lds
  s_add_u32 m0, s26, 49152
  s_add_u32 s28, s25, 57344
  buffer_load_dwordx4 v4, s[12:15], s28 offen lds
  s_add_u32 m0, s26, 50176
  s_add_u32 s28, s25, 57408
  buffer_load_dwordx4 v4, s[12:15], s28 offen lds
  s_add_u32 m0, s26, 51200
  s_add_u32 s28, s25, 57472
  buffer_load_dwordx4 v4, s[12:15], s28 offen lds
  s_add_u32 m0, s26, 52224
  s_add_u32 s28, s27, 57344
  buffer_load_dwordx4 v4, s[12:15], s28 offen lds
  s_waitcnt vmcnt(8)
Lxd:
  s_barrier
  s_add_u32 m0, s26, 65536
  s_add_u32 s28, s24, 8192
  buffer_load_dwordx4 v2, s[8:11], s28 offen offset:0 lds
  buffer_load_dwordx4 v2, s[8:11], s28 offen offset:1024 lds
  buffer_load_dwordx4 v2, s[8:11], s28 offen offset:2048 lds
  buffer_load_dwordx4 v2, s[8:11], s28 offen offset:3072 lds
  s_add_u32 m0, s26, 81920
  s_add_u32 s28, s25, 114688
  buffer_load_dwordx4 v4, s[12:15], s28 offen lds
  s_add_u32 m0, s26, 82944
  s_add_u32 s28, s25, 114752
  buffer_load_dwordx4 v4, s[12:15], s28 offen lds
  s_add_u32 m0, s26, 83968
  s_add_u32 s28, s25, 114816
  buffer_load_dwordx4 v4, s[12:15], s28 offen lds
  s_add_u32 m0, s26, 84992
  s_add_u32 s28, s27, 114688
  buffer_load_dwordx4 v4, s[12:15], s28 offen lds
  s_add_u32 m0, s26, 98304
  s_add_u32 s28, s24, 12288
  buffer_load_dwordx4 v2, s[8:11], s28 offen offset:0 lds
  buffer_load_dwordx4 v2, s[8:11], s28 offen offset:1024 lds
  buffer_load_dwordx4 v2, s[8:11], s28 offen offset:2048 lds
  buffer_load_dwordx4 v2, s[8:11], s28 offen offset:3072 lds
  s_add_u32 m0, s26, 114688
  s_add_u32 s28, s25, 172032
  buffer_load_dwordx4 v4, s[12:15], s28 offen lds
  s_add_u32 m0, s26, 115712
  s_add_u32 s28, s25, 172096
  buffer_load_dwordx4 v4, s[12:15], s28 offen lds
  s_add_u32 m0, s26, 116736
  s_add_u32 s28, s25, 172160
  buffer_load_dwordx4 v4, s[12:15], s28 offen lds
  s_add_u32 m0, s26, 117760
  s_add_u32 s28, s27, 172032
  buffer_load_dwordx4 v4, s[12:15], s28 offen lds
  s_waitcnt vmcnt(16)
  s_barrier
  s_add_u32 m0, s26, 0
  s_add_u32 s28, s24, 16384
  buffer_load_dwordx4 v2, s[8:11], s28 offen offset:0 lds
  buffer_load_dwordx4 v2, s[8:11], s28 offen offset:1024 lds
  buffer_load_dwordx4 v2, s[8:11], s28 offen offset:2048 lds
  buffer_load_dwordx4 v2, s[8:11], s28 offen offset:3072 lds
  s_add_u32 m0, s26, 16384
  s_add_u32 s28, s25, 229376
  buffer_load_dwordx4 v4, s[12:15], s28 offen lds
  s_add_u32 m0, s26, 17408
  s_add_u32 s28, s25, 229440
  buffer_load_dwordx4 v4, s[12:15], s28 offen lds
  s_add_u32 m0, s26, 18432
  s_add_u32 s28, s25, 229504
  buffer_load_dwordx4 v4, s[12:15], s28 offen lds
  s_add_u32 m0, s26, 19456
  s_add_u32 s28, s27, 229376
  buffer_load_dwordx4 v4, s[12:15], s28 offen lds
  s_waitcnt vmcnt(16)
  s_barrier
  s_add_u32 m0, s26, 32768
  s_add_u32 s28, s24, 20480
  buffer_load_dwordx4 v2, s[8:11], s28 offen offset:0 lds
  buffer_load_dwordx4 v2, s[8:11], s28 offen offset:1024 lds
  buffer_load_dwordx4 v2, s[8:11], s28 offen offset:2048 lds
  buffer_load_dwordx4 v2, s[8:11], s28 offen offset:3072 lds
  s_add_u32 m0, s26, 49152
  s_add_u32 s28, s25, 286720
  buffer_load_dwordx4 v4, s[12:15], s28 offen lds
  s_add_u32 m0, s26, 50176
  s_add_u32 s28, s25, 286784
  buffer_load_dwordx4 v4, s[12:15], s28 offen lds
  s_add_u32 m0, s26, 51200
  s_add_u32 s28, s25, 286848
  buffer_load_dwordx4 v4, s[12:15], s28 offen lds
  s_add_u32 m0, s26, 52224
  s_add_u32 s28, s27, 286720
  buffer_load_dwordx4 v4, s[12:15], s28 offen lds
  s_waitcnt vmcnt(16)
  s_barrier
  s_add_u32 m0, s26, 65536
  s_add_u32 s28, s24, 24576
  buffer_load_dwordx4 v2, s[8:11], s28 offen offset:0 lds
  buffer_load_dwordx4 v2, s[8:11], s28 offen offset:1024 lds
  buffer_load_dwordx4 v2, s[8:11], s28 offen offset:2048 lds
  buffer_load_dwordx4 v2, s[8:11], s28 offen offset:3072 lds
  s_add_u32 m0, s26, 81920
  s_add_u32 s28, s25, 344064
  buffer_load_dwordx4 v4, s[12:15], s28 offen lds
  s_add_u32 m0, s26, 82944
  s_add_u32 s28, s25, 344128
  buffer_load_dwordx4 v4, s[12:15], s28 offen lds
  s_add_u32 m0, s26, 83968
  s_add_u32 s28, s25, 344192
  buffer_load_dwordx4 v4, s[12:15], s28 offen lds
  s_add_u32 m0, s26, 84992
  s_add_u32 s28, s27, 344064
  buffer_load_dwordx4 v4, s[12:15], s28 offen lds
  s_waitcnt vmcnt(16)
  s_barrier
  s_waitcnt vmcnt(8)
  s_barrier
  s_waitcnt vmcnt(0)
  s_barrier
  s_getpc_b64 s[12:13]
Lpc_k2:
  s_add_u32 s12, s12, ftab-Lpc_k2
  s_addc_u32 s13, s13, 0
  s_mov_b32 s14, 401408
  s_mov_b32 s15, 0x20000
  s_lshr_b32 s28, s2, 3
  s_lshl_b32 s28, s28, 2
  s_add_u32 s28, s28, s22
  s_mul_i32 s28, s28, 3200
  v_and_b32 v2, 31, v1
  v_lshlrev_b32 v2, 7, v2
  buffer_load_dword v3, v2, s[12:15], s28 offen
  s_waitcnt vmcnt(0)
  s_branch Lfin2
Lg2:
  s_add_u32 s16, s6, 0xd00000
  s_addc_u32 s17, s7, 0
  s_mov_b32 s18, 0x700000
  s_mov_b32 s19, 0x20000
  s_and_b32 s32, s22, 1
  s_lshr_b32 s33, s22, 1
  v_lshlrev_b32 v2, 4, v1
  s_lshl_b32 s28, s32, 13
  v_add_u32 v8, s28, v2
  v_add_u32 v9, 65536, v8
  v_lshrrev_b32 v10, 5, v1
  v_bfe_u32 v17, v1, 2, 2
  v_lshl_add_u32 v10, v10, 3, v17
  v_lshlrev_b32 v10, 6, v10
  v_bfe_u32 v17, v1, 4, 1
  v_and_b32 v18, 3, v1
  v_lshl_add_u32 v17, v17, 2, v18
  v_lshlrev_b32 v17, 2, v17
  v_lshrrev_b32 v18, 1, v17
  v_xor_b32 v18, v18, v17
  v_and_b32 v18, 4, v18
  v_mul_u32_u24 v18, 3, v18
  v_xor_b32 v17, v17, v18
  v_lshl_add_u32 v10, v17, 1, v10
  s_lshl_b32 s28, s33, 11
  s_add_u32 s28, s28, 16384
  v_add_u32 v10, s28, v10
  v_add_u32 v11, 65536, v10
  s_lshl_b32 s28, s20, 6
  s_add_u32 s28, s28, s23
  s_lshl_b32 s29, s32, 1
  s_add_u32 s28, s28, s29
  s_mul_i32 s28, s28, 28
  s_lshl_b32 s29, s33, 1
  s_add_u32 s29, s29, s30
  s_lshl_b32 s29, s29, 1
  s_add_u32 s28, s28, s29
  s_lshl_b32 s28, s28, 10
  s_add_u32 s29, s28, 28672
  s_and_b32 s31, s33, s21
  s_barrier
  ds_read_b128 v[24:27], v8 offset:0
  ds_read_b64_tr_b16 v[32:33], v10 offset:0
  ds_read_b64_tr_b16 v[34:35], v10 offset:256
  ds_read_b128 v[28:31], v8 offset:4096
  ds_read_b64_tr_b16 v[36:37], v10 offset:1024
  ds_read_b64_tr_b16 v[38:39], v10 offset:1280
  s_waitcnt lgkmcnt(0)
  v_mfma_f32_32x32x16_bf16 v[64:79], v[32:35], v[24:27], 0
  ds_read_b128 v[40:43], v8 offset:1024
  ds_read_b64_tr_b16 v[48:49], v10 offset:4096
  ds_read_b64_tr_b16 v[50:51], v10 offset:4352
  v_mfma_f32_32x32x16_bf16 v[96:111], v[32:35], v[28:31], 0
  ds_read_b128 v[44:47], v8 offset:5120
  ds_read_b64_tr_b16 v[52:53], v10 offset:5120
  ds_read_b64_tr_b16 v[54:55], v10 offset:5376
  v_mfma_f32_32x32x16_bf16 v[112:127], v[36:39], v[28:31], 0
  v_mfma_f32_32x32x16_bf16 v[80:95], v[36:39], v[24:27], 0
  s_waitcnt lgkmcnt(0)
  v_mfma_f32_32x32x16_bf16 v[64:79], v[48:51], v[40:43], v[64:79]
  ds_read_b128 v[24:27], v8 offset:2048
  ds_read_b64_tr_b16 v[32:33], v10 offset:8192
  ds_read_b64_tr_b16 v[34:35], v10 offset:8448
  v_mfma_f32_32x32x16_bf16 v[96:111], v[48:51], v[44:47], v[96:111]
  ds_read_b128 v[28:31], v8 offset:6144
  ds_read_b64_tr_b16 v[36:37], v10 offset:9216
  ds_read_b64_tr_b16 v[38:39], v10 offset:9472
  v_mfma_f32_32x32x16_bf16 v[112:127], v[52:55], v[44:47], v[112:127]
  v_mfma_f32_32x32x16_bf16 v[80:95], v[52:55], v[40:43], v[80:95]
  s_waitcnt lgkmcnt(0)
  v_mfma_f32_32x32x16_bf16 v[64:79], v[32:35], v[24:27], v[64:79]
  ds_read_b128 v[40:43], v8 offset:3072
  ds_read_b64_tr_b16 v[48:49], v10 offset:12288
  ds_read_b64_tr_b16 v[50:51], v10 offset:12544
  v_mfma_f32_32x32x16_bf16 v[96:111], v[32:35], v[28:31], v[96:111]
  ds_read_b128 v[44:47], v8 offset:7168
  ds_read_b64_tr_b16 v[52:53], v10 offset:13312
  ds_read_b64_tr_b16 v[54:55], v10 offset:13568
  v_mfma_f32_32x32x16_bf16 v[112:127], v[36:39], v[28:31], v[112:127]
  v_mfma_f32_32x32x16_bf16 v[80:95], v[36:39], v[24:27], v[80:95]
  s_waitcnt lgkmcnt(0)
  s_barrier
  v_mfma_f32_32x32x16_bf16 v[64:79], v[48:51], v[40:43], v[64:79]
  ds_read_b128 v[24:27], v8 offset:32768
  ds_read_b64_tr_b16 v[32:33], v10 offset:32768
  ds_read_b64_tr_b16 v[34:35], v10 offset:33024
  v_mfma_f32_32x32x16_bf16 v[96:111], v[48:51], v[44:47], v[96:111]
  ds_read_b128 v[28:31], v8 offset:36864
  ds_read_b64_tr_b16 v[36:37], v10 offset:33792
  ds_read_b64_tr_b16 v[38:39], v10 offset:34048
  v_mfma_f32_32x32x16_bf16 v[112:127], v[52:55], v[44:47], v[112:127]
  v_mfma_f32_32x32x16_bf16 v[80:95], v[52:55], v[40:43], v[80:95]
  s_waitcnt lgkmcnt(0)
  v_mfma_f32_32x32x16_bf16 v[64:79], v[32:35], v[24:27], v[64:79]
  ds_read_b128 v[40:43], v8 offset:33792
  ds_read_b64_tr_b16 v[48:49], v10 offset:36864
  ds_read_b64_tr_b16 v[50:51], v10 offset:37120
  v_mfma_f32_32x32x16_bf16 v[96:111], v[32:35], v[28:31], v[96:111]
  ds_read_b128 v[44:47], v8 offset:37888
  ds_read_b64_tr_b16 v[52:53], v10 offset:37888
  ds_read_b64_tr_b16 v[54:55], v10 offset:38144
  v_mfma_f32_32x32x16_bf16 v[112:127], v[36:39], v[28:31], v[112:127]
  v_mfma_f32_32x32x16_bf16 v[80:95], v[36:39], v[24:27], v[80:95]
  s_waitcnt lgkmcnt(0)
  v_mfma_f32_32x32x16_bf16 v[64:79], v[48:51], v[40:43], v[64:79]
  ds_read_b128 v[24:27], v8 offset:34816
  ds_read_b64_tr_b16 v[32:33], v10 offset:40960
  ds_read_b64_tr_b16 v[34:35], v10 offset:41216
  v_mfma_f32_32x32x16_bf16 v[96:111], v[48:51], v[44:47], v[96:111]
  ds_read_b128 v[28:31], v8 offset:38912
  ds_read_b64_tr_b16 v[36:37], v10 offset:41984
  ds_read_b64_tr_b16 v[38:39], v10 offset:42240
  v_mfma_f32_32x32x16_bf16 v[112:127], v[52:55], v[44:47], v[112:127]
  v_mfma_f32_32x32x16_bf16 v[80:95], v[52:55], v[40:43], v[80:95]
  s_waitcnt lgkmcnt(0)
  v_mfma_f32_32x32x16_bf16 v[64:79], v[32:35], v[24:27], v[64:79]
  ds_read_b128 v[40:43], v8 offset:35840
  ds_read_b64_tr_b16 v[48:49], v10 offset:45056
  ds_read_b64_tr_b16 v[50:51], v10 offset:45312
  v_mfma_f32_32x32x16_bf16 v[96:111], v[32:35], v[28:31], v[96:111]
  ds_read_b128 v[44:47], v8 offset:39936
  ds_read_b64_tr_b16 v[52:53], v10 offset:46080
  ds_read_b64_tr_b16 v[54:55], v10 offset:46336
  v_mfma_f32_32x32x16_bf16 v[112:127], v[36:39], v[28:31], v[112:127]
  v_mfma_f32_32x32x16_bf16 v[80:95], v[36:39], v[24:27], v[80:95]
  s_waitcnt lgkmcnt(0)
  s_barrier
  v_mfma_f32_32x32x16_bf16 v[64:79], v[48:51], v[40:43], v[64:79]
  ds_read_b128 v[24:27], v9 offset:0
  ds_read_b64_tr_b16 v[32:33], v11 offset:0
  ds_read_b64_tr_b16 v[34:35], v11 offset:256
  v_mfma_f32_32x32x16_bf16 v[96:111], v[48:51], v[44:47], v[96:111]
  ds_read_b128 v[28:31], v9 offset:4096
  ds_read_b64_tr_b16 v[36:37], v11 offset:1024
  ds_read_b64_tr_b16 v[38:39], v11 offset:1280
  v_mfma_f32_32x32x16_bf16 v[112:127], v[52:55], v[44:47], v[112:127]
  v_mfma_f32_32x32x16_bf16 v[80:95], v[52:55], v[40:43], v[80:95]
  s_waitcnt lgkmcnt(0)
  v_mfma_f32_32x32x16_bf16 v[64:79], v[32:35], v[24:27], v[64:79]
  ds_read_b128 v[40:43], v9 offset:1024
  ds_read_b64_tr_b16 v[48:49], v11 offset:4096
  ds_read_b64_tr_b16 v[50:51], v11 offset:4352
  v_mfma_f32_32x32x16_bf16 v[96:111], v[32:35], v[28:31], v[96:111]
  ds_read_b128 v[44:47], v9 offset:5120
  ds_read_b64_tr_b16 v[52:53], v11 offset:5120
  ds_read_b64_tr_b16 v[54:55], v11 offset:5376
  v_mfma_f32_32x32x16_bf16 v[112:127], v[36:39], v[28:31], v[112:127]
  v_mfma_f32_32x32x16_bf16 v[80:95], v[36:39], v[24:27], v[80:95]
  s_waitcnt lgkmcnt(0)
  v_mfma_f32_32x32x16_bf16 v[64:79], v[48:51], v[40:43], v[64:79]
  ds_read_b128 v[24:27], v9 offset:2048
  ds_read_b64_tr_b16 v[32:33], v11 offset:8192
  ds_read_b64_tr_b16 v[34:35], v11 offset:8448
  v_mfma_f32_32x32x16_bf16 v[96:111], v[48:51], v[44:47], v[96:111]
  ds_read_b128 v[28:31], v9 offset:6144
  ds_read_b64_tr_b16 v[36:37], v11 offset:9216
  ds_read_b64_tr_b16 v[38:39], v11 offset:9472
  v_mfma_f32_32x32x16_bf16 v[112:127], v[52:55], v[44:47], v[112:127]
  v_mfma_f32_32x32x16_bf16 v[80:95], v[52:55], v[40:43], v[80:95]
  s_waitcnt lgkmcnt(0)
  v_mfma_f32_32x32x16_bf16 v[64:79], v[32:35], v[24:27], v[64:79]
  ds_read_b128 v[40:43], v9 offset:3072
  ds_read_b64_tr_b16 v[48:49], v11 offset:12288
  ds_read_b64_tr_b16 v[50:51], v11 offset:12544
  v_mfma_f32_32x32x16_bf16 v[96:111], v[32:35], v[28:31], v[96:111]
  ds_read_b128 v[44:47], v9 offset:7168
  ds_read_b64_tr_b16 v[52:53], v11 offset:13312
  ds_read_b64_tr_b16 v[54:55], v11 offset:13568
  v_mfma_f32_32x32x16_bf16 v[112:127], v[36:39], v[28:31], v[112:127]
  v_mfma_f32_32x32x16_bf16 v[80:95], v[36:39], v[24:27], v[80:95]
  s_waitcnt lgkmcnt(0)
  s_barrier
  v_mfma_f32_32x32x16_bf16 v[64:79], v[48:51], v[40:43], v[64:79]
  ds_read_b128 v[24:27], v9 offset:32768
  ds_read_b64_tr_b16 v[32:33], v11 offset:32768
  ds_read_b64_tr_b16 v[34:35], v11 offset:33024
  v_mfma_f32_32x32x16_bf16 v[96:111], v[48:51], v[44:47], v[96:111]
  ds_read_b128 v[28:31], v9 offset:36864
  ds_read_b64_tr_b16 v[36:37], v11 offset:33792
  ds_read_b64_tr_b16 v[38:39], v11 offset:34048
  v_mfma_f32_32x32x16_bf16 v[112:127], v[52:55], v[44:47], v[112:127]
  v_mfma_f32_32x32x16_bf16 v[80:95], v[52:55], v[40:43], v[80:95]
  s_waitcnt lgkmcnt(0)
  v_mfma_f32_32x32x16_bf16 v[64:79], v[32:35], v[24:27], v[64:79]
  ds_read_b128 v[40:43], v9 offset:33792
  ds_read_b64_tr_b16 v[48:49], v11 offset:36864
  ds_read_b64_tr_b16 v[50:51], v11 offset:37120
  v_mfma_f32_32x32x16_bf16 v[96:111], v[32:35], v[28:31], v[96:111]
  ds_read_b128 v[44:47], v9 offset:37888
  ds_read_b64_tr_b16 v[52:53], v11 offset:37888
  ds_read_b64_tr_b16 v[54:55], v11 offset:38144
  v_mfma_f32_32x32x16_bf16 v[112:127], v[36:39], v[28:31], v[112:127]
  v_mfma_f32_32x32x16_bf16 v[80:95], v[36:39], v[24:27], v[80:95]
  s_waitcnt lgkmcnt(0)
  v_mfma_f32_32x32x16_bf16 v[64:79], v[48:51], v[40:43], v[64:79]
  ds_read_b128 v[24:27], v9 offset:34816
  ds_read_b64_tr_b16 v[32:33], v11 offset:40960
  ds_read_b64_tr_b16 v[34:35], v11 offset:41216
  v_mfma_f32_32x32x16_bf16 v[96:111], v[48:51], v[44:47], v[96:111]
  ds_read_b128 v[28:31], v9 offset:38912
  ds_read_b64_tr_b16 v[36:37], v11 offset:41984
  ds_read_b64_tr_b16 v[38:39], v11 offset:42240
  v_mfma_f32_32x32x16_bf16 v[112:127], v[52:55], v[44:47], v[112:127]
  v_mfma_f32_32x32x16_bf16 v[80:95], v[52:55], v[40:43], v[80:95]
  s_waitcnt lgkmcnt(0)
  v_mfma_f32_32x32x16_bf16 v[64:79], v[32:35], v[24:27], v[64:79]
  ds_read_b128 v[40:43], v9 offset:35840
  ds_read_b64_tr_b16 v[48:49], v11 offset:45056
  ds_read_b64_tr_b16 v[50:51], v11 offset:45312
  v_mfma_f32_32x32x16_bf16 v[96:111], v[32:35], v[28:31], v[96:111]
  ds_read_b128 v[44:47], v9 offset:39936
  ds_read_b64_tr_b16 v[52:53], v11 offset:46080
  ds_read_b64_tr_b16 v[54:55], v11 offset:46336
  v_mfma_f32_32x32x16_bf16 v[112:127], v[36:39], v[28:31], v[112:127]
  v_mfma_f32_32x32x16_bf16 v[80:95], v[36:39], v[24:27], v[80:95]
  s_waitcnt lgkmcnt(0)
  s_barrier
  v_mfma_f32_32x32x16_bf16 v[64:79], v[48:51], v[40:43], v[64:79]
  ds_read_b128 v[24:27], v8 offset:0
  ds_read_b64_tr_b16 v[32:33], v10 offset:0
  ds_read_b64_tr_b16 v[34:35], v10 offset:256
  v_mfma_f32_32x32x16_bf16 v[96:111], v[48:51], v[44:47], v[96:111]
  ds_read_b128 v[28:31], v8 offset:4096
  ds_read_b64_tr_b16 v[36:37], v10 offset:1024
  ds_read_b64_tr_b16 v[38:39], v10 offset:1280
  v_mfma_f32_32x32x16_bf16 v[112:127], v[52:55], v[44:47], v[112:127]
  v_mfma_f32_32x32x16_bf16 v[80:95], v[52:55], v[40:43], v[80:95]
  s_waitcnt lgkmcnt(0)
  v_mfma_f32_32x32x16_bf16 v[64:79], v[32:35], v[24:27], v[64:79]
  ds_read_b128 v[40:43], v8 offset:1024
  ds_read_b64_tr_b16 v[48:49], v10 offset:4096
  ds_read_b64_tr_b16 v[50:51], v10 offset:4352
  v_mfma_f32_32x32x16_bf16 v[96:111], v[32:35], v[28:31], v[96:111]
  ds_read_b128 v[44:47], v8 offset:5120
  ds_read_b64_tr_b16 v[52:53], v10 offset:5120
  ds_read_b64_tr_b16 v[54:55], v10 offset:5376
  v_mfma_f32_32x32x16_bf16 v[112:127], v[36:39], v[28:31], v[112:127]
  v_mfma_f32_32x32x16_bf16 v[80:95], v[36:39], v[24:27], v[80:95]
  s_waitcnt lgkmcnt(0)
  v_mfma_f32_32x32x16_bf16 v[64:79], v[48:51], v[40:43], v[64:79]
  ds_read_b128 v[24:27], v8 offset:2048
  ds_read_b64_tr_b16 v[32:33], v10 offset:8192
  ds_read_b64_tr_b16 v[34:35], v10 offset:8448
  v_mfma_f32_32x32x16_bf16 v[96:111], v[48:51], v[44:47], v[96:111]
  ds_read_b128 v[28:31], v8 offset:6144
  ds_read_b64_tr_b16 v[36:37], v10 offset:9216
  ds_read_b64_tr_b16 v[38:39], v10 offset:9472
  v_mfma_f32_32x32x16_bf16 v[112:127], v[52:55], v[44:47], v[112:127]
  v_mfma_f32_32x32x16_bf16 v[80:95], v[52:55], v[40:43], v[80:95]
  s_waitcnt lgkmcnt(0)
  v_mfma_f32_32x32x16_bf16 v[64:79], v[32:35], v[24:27], v[64:79]
  ds_read_b128 v[40:43], v8 offset:3072
  ds_read_b64_tr_b16 v[48:49], v10 offset:12288
  ds_read_b64_tr_b16 v[50:51], v10 offset:12544
  v_mfma_f32_32x32x16_bf16 v[96:111], v[32:35], v[28:31], v[96:111]
  ds_read_b128 v[44:47], v8 offset:7168
  ds_read_b64_tr_b16 v[52:53], v10 offset:13312
  ds_read_b64_tr_b16 v[54:55], v10 offset:13568
  v_mfma_f32_32x32x16_bf16 v[112:127], v[36:39], v[28:31], v[112:127]
  v_mfma_f32_32x32x16_bf16 v[80:95], v[36:39], v[24:27], v[80:95]
  s_waitcnt lgkmcnt(0)
  s_barrier
  v_mfma_f32_32x32x16_bf16 v[64:79], v[48:51], v[40:43], v[64:79]
  ds_read_b128 v[24:27], v8 offset:32768
  ds_read_b64_tr_b16 v[32:33], v10 offset:32768
  ds_read_b64_tr_b16 v[34:35], v10 offset:33024
  v_mfma_f32_32x32x16_bf16 v[96:111], v[48:51], v[44:47], v[96:111]
  ds_read_b128 v[28:31], v8 offset:36864
  ds_read_b64_tr_b16 v[36:37], v10 offset:33792
  ds_read_b64_tr_b16 v[38:39], v10 offset:34048
  v_mfma_f32_32x32x16_bf16 v[112:127], v[52:55], v[44:47], v[112:127]
  v_mfma_f32_32x32x16_bf16 v[80:95], v[52:55], v[40:43], v[80:95]
  s_waitcnt lgkmcnt(0)
  v_mfma_f32_32x32x16_bf16 v[64:79], v[32:35], v[24:27], v[64:79]
  ds_read_b128 v[40:43], v8 offset:33792
  ds_read_b64_tr_b16 v[48:49], v10 offset:36864
  ds_read_b64_tr_b16 v[50:51], v10 offset:37120
  v_mfma_f32_32x32x16_bf16 v[96:111], v[32:35], v[28:31], v[96:111]
  ds_read_b128 v[44:47], v8 offset:37888
  ds_read_b64_tr_b16 v[52:53], v10 offset:37888
  ds_read_b64_tr_b16 v[54:55], v10 offset:38144
  v_mfma_f32_32x32x16_bf16 v[112:127], v[36:39], v[28:31], v[112:127]
  v_mfma_f32_32x32x16_bf16 v[80:95], v[36:39], v[24:27], v[80:95]
  s_waitcnt lgkmcnt(0)
  v_mfma_f32_32x32x16_bf16 v[64:79], v[48:51], v[40:43], v[64:79]
  ds_read_b128 v[24:27], v8 offset:34816
  ds_read_b64_tr_b16 v[32:33], v10 offset:40960
  ds_read_b64_tr_b16 v[34:35], v10 offset:41216
  v_mfma_f32_32x32x16_bf16 v[96:111], v[48:51], v[44:47], v[96:111]
  ds_read_b128 v[28:31], v8 offset:38912
  ds_read_b64_tr_b16 v[36:37], v10 offset:41984
  ds_read_b64_tr_b16 v[38:39], v10 offset:42240
  v_mfma_f32_32x32x16_bf16 v[112:127], v[52:55], v[44:47], v[112:127]
  v_mfma_f32_32x32x16_bf16 v[80:95], v[52:55], v[40:43], v[80:95]
  s_waitcnt lgkmcnt(0)
  v_mfma_f32_32x32x16_bf16 v[64:79], v[32:35], v[24:27], v[64:79]
  ds_read_b128 v[40:43], v8 offset:35840
  ds_read_b64_tr_b16 v[48:49], v10 offset:45056
  ds_read_b64_tr_b16 v[50:51], v10 offset:45312
  v_mfma_f32_32x32x16_bf16 v[96:111], v[32:35], v[28:31], v[96:111]
  ds_read_b128 v[44:47], v8 offset:39936
  ds_read_b64_tr_b16 v[52:53], v10 offset:46080
  ds_read_b64_tr_b16 v[54:55], v10 offset:46336
  v_mfma_f32_32x32x16_bf16 v[112:127], v[36:39], v[28:31], v[112:127]
  v_mfma_f32_32x32x16_bf16 v[80:95], v[36:39], v[24:27], v[80:95]
  s_waitcnt lgkmcnt(0)
  s_barrier
  v_mfma_f32_32x32x16_bf16 v[64:79], v[48:51], v[40:43], v[64:79]
  ds_read_b128 v[24:27], v9 offset:0
  ds_read_b64_tr_b16 v[32:33], v11 offset:0
  ds_read_b64_tr_b16 v[34:35], v11 offset:256
  v_mfma_f32_32x32x16_bf16 v[96:111], v[48:51], v[44:47], v[96:111]
  ds_read_b128 v[28:31], v9 offset:4096
  ds_read_b64_tr_b16 v[36:37], v11 offset:1024
  ds_read_b64_tr_b16 v[38:39], v11 offset:1280
  v_mfma_f32_32x32x16_bf16 v[112:127], v[52:55], v[44:47], v[112:127]
  v_mfma_f32_32x32x16_bf16 v[80:95], v[52:55], v[40:43], v[80:95]
  s_waitcnt lgkmcnt(0)
  v_mfma_f32_32x32x16_bf16 v[64:79], v[32:35], v[24:27], v[64:79]
  ds_read_b128 v[40:43], v9 offset:1024
  ds_read_b64_tr_b16 v[48:49], v11 offset:4096
  ds_read_b64_tr_b16 v[50:51], v11 offset:4352
  v_mfma_f32_32x32x16_bf16 v[96:111], v[32:35], v[28:31], v[96:111]
  ds_read_b128 v[44:47], v9 offset:5120
  ds_read_b64_tr_b16 v[52:53], v11 offset:5120
  ds_read_b64_tr_b16 v[54:55], v11 offset:5376
  v_mfma_f32_32x32x16_bf16 v[112:127], v[36:39], v[28:31], v[112:127]
  v_mfma_f32_32x32x16_bf16 v[80:95], v[36:39], v[24:27], v[80:95]
  s_waitcnt lgkmcnt(0)
  v_mfma_f32_32x32x16_bf16 v[64:79], v[48:51], v[40:43], v[64:79]
  ds_read_b128 v[24:27], v9 offset:2048
  ds_read_b64_tr_b16 v[32:33], v11 offset:8192
  ds_read_b64_tr_b16 v[34:35], v11 offset:8448
  v_mfma_f32_32x32x16_bf16 v[96:111], v[48:51], v[44:47], v[96:111]
  ds_read_b128 v[28:31], v9 offset:6144
  ds_read_b64_tr_b16 v[36:37], v11 offset:9216
  ds_read_b64_tr_b16 v[38:39], v11 offset:9472
  v_mfma_f32_32x32x16_bf16 v[112:127], v[52:55], v[44:47], v[112:127]
  v_mfma_f32_32x32x16_bf16 v[80:95], v[52:55], v[40:43], v[80:95]
  s_waitcnt lgkmcnt(0)
  v_mfma_f32_32x32x16_bf16 v[64:79], v[32:35], v[24:27], v[64:79]
  ds_read_b128 v[40:43], v9 offset:3072
  ds_read_b64_tr_b16 v[48:49], v11 offset:12288
  ds_read_b64_tr_b16 v[50:51], v11 offset:12544
  v_mfma_f32_32x32x16_bf16 v[96:111], v[32:35], v[28:31], v[96:111]
  ds_read_b128 v[44:47], v9 offset:7168
  ds_read_b64_tr_b16 v[52:53], v11 offset:13312
  ds_read_b64_tr_b16 v[54:55], v11 offset:13568
  v_mfma_f32_32x32x16_bf16 v[112:127], v[36:39], v[28:31], v[112:127]
  v_mfma_f32_32x32x16_bf16 v[80:95], v[36:39], v[24:27], v[80:95]
  s_waitcnt lgkmcnt(0)
  v_mfma_f32_32x32x16_bf16 v[64:79], v[48:51], v[40:43], v[64:79]
  v_mfma_f32_32x32x16_bf16 v[96:111], v[48:51], v[44:47], v[96:111]
  v_mfma_f32_32x32x16_bf16 v[112:127], v[52:55], v[44:47], v[112:127]
  v_mfma_f32_32x32x16_bf16 v[80:95], v[52:55], v[40:43], v[80:95]
  s_nop 7
  v_cvt_pk_bf16_f32 v64, v64, v65
  v_cvt_pk_bf16_f32 v65, v66, v67
  v_cvt_pk_bf16_f32 v66, v68, v69
  v_cvt_pk_bf16_f32 v67, v70, v71
  v_cvt_pk_bf16_f32 v68, v72, v73
  v_cvt_pk_bf16_f32 v69, v74, v75
  v_cvt_pk_bf16_f32 v70, v76, v77
  v_cvt_pk_bf16_f32 v71, v78, v79
  buffer_store_dwordx4 v[64:67], v2, s[16:19], s28 offen offset:0 sc1
  buffer_store_dwordx4 v[68:71], v2, s[16:19], s28 offen offset:1024 sc1
  v_cvt_pk_bf16_f32 v96, v96, v97
  v_cvt_pk_bf16_f32 v97, v98, v99
  v_cvt_pk_bf16_f32 v98, v100, v101
  v_cvt_pk_bf16_f32 v99, v102, v103
  v_cvt_pk_bf16_f32 v100, v104, v105
  v_cvt_pk_bf16_f32 v101, v106, v107
  v_cvt_pk_bf16_f32 v102, v108, v109
  v_cvt_pk_bf16_f32 v103, v110, v111
  buffer_store_dwordx4 v[96:99], v2, s[16:19], s29 offen offset:0 sc1
  buffer_store_dwordx4 v[100:103], v2, s[16:19], s29 offen offset:1024 sc1
  s_bitcmp1_b32 s31, 0
  s_cbranch_scc1 Lfin2
  v_cvt_pk_bf16_f32 v112, v112, v113
  v_cvt_pk_bf16_f32 v113, v114, v115
  v_cvt_pk_bf16_f32 v114, v116, v117
  v_cvt_pk_bf16_f32 v115, v118, v119
  v_cvt_pk_bf16_f32 v116, v120, v121
  v_cvt_pk_bf16_f32 v117, v122, v123
  v_cvt_pk_bf16_f32 v118, v124, v125
  v_cvt_pk_bf16_f32 v119, v126, v127
  buffer_store_dwordx4 v[112:115], v2, s[16:19], s29 offen offset:2048 sc1
  buffer_store_dwordx4 v[116:119], v2, s[16:19], s29 offen offset:3072 sc1
  v_cvt_pk_bf16_f32 v80, v80, v81
  v_cvt_pk_bf16_f32 v81, v82, v83
  v_cvt_pk_bf16_f32 v82, v84, v85
  v_cvt_pk_bf16_f32 v83, v86, v87
  v_cvt_pk_bf16_f32 v84, v88, v89
  v_cvt_pk_bf16_f32 v85, v90, v91
  v_cvt_pk_bf16_f32 v86, v92, v93
  v_cvt_pk_bf16_f32 v87, v94, v95
  buffer_store_dwordx4 v[80:83], v2, s[16:19], s28 offen offset:2048 sc1
  buffer_store_dwordx4 v[84:87], v2, s[16:19], s28 offen offset:3072 sc1
  s_branch Lfin2
Lfin2:
Lend2:
  s_endpgm
.globl k3_kernel
.p2align 8
.type k3_kernel,@function
k3_kernel:
  s_cmp_ge_u32 s2, 224
  s_cbranch_scc1 Lend3
  s_load_dwordx2 s[4:5], s[0:1], 0
  s_load_dwordx2 s[6:7], s[0:1], 64
  s_load_dwordx2 s[20:21], s[0:1], 48
  v_lshrrev_b32 v2, 6, v0
  v_and_b32 v1, 63, v0
  v_readfirstlane_b32 s3, v2
  s_lshr_b32 s28, s2, 3
  s_and_b32 s30, s2, 3
  s_lshl_b32 s30, s30, 3
  s_and_b32 s29, s2, 4
  s_add_u32 s30, s30, s29
  s_and_b32 s29, s28, 3
  s_add_u32 s30, s30, s29
  s_lshr_b32 s31, s28, 2
  s_and_b32 s32, s3, 1
  s_lshr_b32 s33, s3, 1
  s_cmp_lt_u32 s3, 4
  s_cbranch_scc1 Lc3
  s_getpc_b64 s[12:13]
Lpc_k3:
  s_add_u32 s12, s12, ftab-Lpc_k3
  s_addc_u32 s13, s13, 0
  s_mov_b32 s14, 401408
  s_mov_b32 s15, 0x20000
  s_setprio 3
  s_and_b32 s22, s3, 3
  v_lshrrev_b32 v8, 3, v1
  v_and_b32 v9, 7, v1
  v_lshrrev_b32 v10, 4, v1
  v_xor_b32 v11, v9, v10
  v_mul_u32_u24 v12, 896, v8
  v_lshl_add_u32 v12, v11, 4, v12
  v_xor_b32 v13, 64, v12
  v_and_b32 v10, 1, v10
  v_lshlrev_b32 v10, 2, v10
  v_xor_b32 v9, v9, v10
  v_mul_u32_u24 v14, 4352, v8
  v_lshl_add_u32 v14, v9, 4, v14
  s_mul_i32 s36, s22, 69632
  s_lshl_b32 s28, s30, 7
  s_add_u32 s36, s36, s28
  s_lshl_b32 s37, s31, 2
  s_add_u32 s37, s37, s22
  s_mul_i32 s37, s37, 14336
  s_lshl_b32 s38, s22, 11
  s_waitcnt lgkmcnt(0)
  s_add_u32 s16, s6, 0xb00000
  s_addc_u32 s17, s7, 0
  s_mov_b32 s18, 0x1dc000
  s_mov_b32 s19, 0x20000
  s_barrier
  s_add_u32 m0, s38, 0
  s_add_u32 s28, s36, 0
  buffer_load_dwordx4 v14, s[16:19], s28 offen lds
  s_add_u32 m0, s38, 1024
  s_add_u32 s28, s36, 34816
  buffer_load_dwordx4 v14, s[16:19], s28 offen lds
  s_add_u32 m0, s38, 57344
  s_add_u32 s28, s37, 0
  buffer_load_dwordx4 v12, s[12:15], s28 offen lds
  s_add_u32 m0, s38, 58368
  s_add_u32 s28, s37, 7168
  buffer_load_dwordx4 v13, s[12:15], s28 offen lds
  s_add_u32 m0, s38, 8192
  s_add_u32 s28, s36, 278528
  buffer_load_dwordx4 v14, s[16:19], s28 offen lds
  s_add_u32 m0, s38, 9216
  s_add_u32 s28, s36, 313344
  buffer_load_dwordx4 v14, s[16:19], s28 offen lds
  s_add_u32 m0, s38, 65536
  s_add_u32 s28, s37, 128
  buffer_load_dwordx4 v12, s[12:15], s28 offen lds
  s_add_u32 m0, s38, 66560
  s_add_u32 s28, s37, 7296
  buffer_load_dwordx4 v13, s[12:15], s28 offen lds
  s_add_u32 m0, s38, 16384
  s_add_u32 s28, s36, 557056
  buffer_load_dwordx4 v14, s[16:19], s28 offen lds
  s_add_u32 m0, s38, 17408
  s_add_u32 s28, s36, 591872
  buffer_load_dwordx4 v14, s[16:19], s28 offen lds
  s_add_u32 m0, s38, 73728
  s_add_u32 s28, s37, 256
  buffer_load_dwordx4 v12, s[12:15], s28 offen lds
  s_add_u32 m0, s38, 74752
  s_add_u32 s28, s37, 7424
  buffer_load_dwordx4 v13, s[12:15], s28 offen lds
  s_add_u32 m0, s38, 24576
  s_add_u32 s28, s36, 835584
  buffer_load_dwordx4 v14, s[16:19], s28 offen lds
  s_add_u32 m0, s38, 25600
  s_add_u32 s28, s36, 870400
  buffer_load_dwordx4 v14, s[16:19], s28 offen lds
  s_add_u32 m0, s38, 81920
  s_add_u32 s28, s37, 384
  buffer_load_dwordx4 v12, s[12:15], s28 offen lds
  s_add_u32 m0, s38, 82944
  s_add_u32 s28, s37, 7552
  buffer_load_dwordx4 v13, s[12:15], s28 offen lds
  s_waitcnt vmcnt(12)
  s_barrier
  s_add_u32 m0, s38, 32768
  s_add_u32 s28, s36, 1114112
  buffer_load_dwordx4 v14, s[16:19], s28 offen lds
  s_add_u32 m0, s38, 33792
  s_add_u32 s28, s36, 1148928
  buffer_load_dwordx4 v14, s[16:19], s28 offen lds
  s_add_u32 m0, s38, 90112
  s_add_u32 s28, s37, 512
  buffer_load_dwordx4 v12, s[12:15], s28 offen lds
  s_add_u32 m0, s38, 91136
  s_add_u32 s28, s37, 7680
  buffer_load_dwordx4 v13, s[12:15], s28 offen lds
  s_waitcnt vmcnt(12)
  s_barrier
  s_add_u32 m0, s38, 40960
  s_add_u32 s28, s36, 1392640
  buffer_load_dwordx4 v14, s[16:19], s28 offen lds
  s_add_u32 m0, s38, 41984
  s_add_u32 s28, s36, 1427456
  buffer_load_dwordx4 v14, s[16:19], s28 offen lds
  s_add_u32 m0, s38, 98304
  s_add_u32 s28, s37, 640
  buffer_load_dwordx4 v12, s[12:15], s28 offen lds
  s_add_u32 m0, s38, 99328
  s_add_u32 s28, s37, 7808
  buffer_load_dwordx4 v13, s[12:15], s28 offen lds
  s_waitcnt vmcnt(12)
  s_barrier
  s_add_u32 m0, s38, 49152
  s_add_u32 s28, s36, 1671168
  buffer_load_dwordx4 v14, s[16:19], s28 offen lds
  s_add_u32 m0, s38, 50176
  s_add_u32 s28, s36, 1705984
  buffer_load_dwordx4 v14, s[16:19], s28 offen lds
  s_add_u32 m0, s38, 106496
  s_add_u32 s28, s37, 768
  buffer_load_dwordx4 v12, s[12:15], s28 offen lds
  s_add_u32 m0, s38, 107520
  s_add_u32 s28, s37, 7936
  buffer_load_dwordx4 v13, s[12:15], s28 offen lds
  s_waitcnt vmcnt(12)
  s_barrier
  s_waitcnt vmcnt(8)
  s_barrier
  s_waitcnt vmcnt(4)
  s_barrier
  s_waitcnt vmcnt(0)
  s_barrier
  s_barrier
  s_branch Lfin3
Lc3:
  s_lshl_b32 s34, s30, 1
  s_add_u32 s34, s34, s32
  s_mul_i32 s34, s34, 28
  s_lshl_b32 s28, s31, 1
  s_add_u32 s28, s28, s33
  s_lshl_b32 s29, s28, 1
  s_add_u32 s34, s34, s29
  s_lshl_b32 s34, s34, 10
  s_lshl_b32 s35, s28, 6
  s_lshl_b32 s28, s32, 10
  s_add_u32 s28, s28, s30
  s_mul_i32 s28, s28, 896
  s_add_u32 s35, s35, s28
  v_lshlrev_b32 v2, 4, v1
  v_and_b32 v5, 31, v1
  v_lshrrev_b32 v6, 5, v1
  v_mul_u32_u24 v3, 28672, v5
  v_lshl_add_u32 v3, v6, 4, v3
  s_waitcnt lgkmcnt(0)
  s_add_u32 s8, s6, 0xd00000
  s_addc_u32 s9, s7, 0
  s_mov_b32 s10, 0x700000
  s_mov_b32 s11, 0x20000
  s_mov_b32 s24, s4
  s_mov_b32 s25, s5
  s_mov_b32 s26, 0x1c0000
  s_mov_b32 s27, 0x20000
  s_mov_b32 s22, 0x1C0000
  s_mov_b32 s23, 0x20000
  buffer_load_dwordx4 v[32:35], v2, s[8:11], s34 offen offset:0
  buffer_load_dwordx4 v[36:39], v2, s[8:11], s34 offen offset:1024
  s_add_u32 s34, s34, 1835008
  buffer_load_dwordx4 v[40:43], v2, s[8:11], s34 offen offset:0
  buffer_load_dwordx4 v[44:47], v2, s[8:11], s34 offen offset:1024
  s_add_u32 s34, s34, 1835008
  buffer_load_dwordx4 v[48:51], v2, s[8:11], s34 offen offset:0
  buffer_load_dwordx4 v[52:55], v2, s[8:11], s34 offen offset:1024
  s_add_u32 s34, s34, 1835008
  buffer_load_dwordx4 v[56:59], v2, s[8:11], s34 offen offset:0
  buffer_load_dwordx4 v[60:63], v2, s[8:11], s34 offen offset:1024
  buffer_load_dwordx4 v[64:67], v3, s[24:27], s35 offen offset:0
  buffer_load_dwordx4 v[68:71], v3, s[24:27], s35 offen offset:32
  s_barrier
  v_mul_u32_u24 v21, 144, v5
  v_lshl_add_u32 v21, v6, 4, v21
  s_mul_i32 s28, s32, 4608
  s_lshl_b32 s29, s33, 6
  s_add_u32 s28, s28, s29
  s_add_u32 s28, s28, 114688
  v_add_u32 v21, s28, v21
  v_lshrrev_b32 v8, 3, v1
  v_and_b32 v9, 7, v1
  v_lshlrev_b32 v9, 4, v9
  v_mul_u32_u24 v22, 144, v8
  s_mul_i32 s28, s3, 2304
  s_add_u32 s28, s28, 114688
  v_add3_u32 v22, v22, v9, s28
  v_mul_u32_u24 v23, 28672, v8
  v_add_u32 v23, v23, v9
  s_lshl_b32 s28, s3, 9
  s_add_u32 s28, s28, s30
  s_mul_i32 s28, s28, 896
  s_lshl_b32 s29, s31, 7
  s_add_u32 s36, s28, s29
  s_add_u32 s37, s36, 229376
  v_lshrrev_b32 v7, 1, v5
  v_xor_b32 v7, v7, v5
  v_and_b32 v7, 4, v7
  v_mul_u32_u24 v7, 3, v7
  v_xor_b32 v5, v5, v7
  s_lshl_b32 s28, s33, 12
  s_add_u32 s28, s28, 57344
  v_bfe_u32 v7, v5, 1, 3
  v_lshlrev_b32 v5, 7, v5
  v_add_u32 v5, s28, v5
  v_add_u32 v8, 0, v6
  v_xor_b32 v8, v8, v7
  v_lshl_add_u32 v16, v8, 4, v5
  v_add_u32 v8, 2, v6
  v_xor_b32 v8, v8, v7
  v_lshl_add_u32 v17, v8, 4, v5
  v_add_u32 v8, 4, v6
  v_xor_b32 v8, v8, v7
  v_lshl_add_u32 v18, v8, 4, v5
  v_add_u32 v8, 6, v6
  v_xor_b32 v8, v8, v7
  v_lshl_add_u32 v19, v8, 4, v5
  v_bfe_u32 v8, v1, 2, 2
  v_lshl_add_u32 v9, v6, 3, v8
  v_lshlrev_b32 v9, 7, v9
  v_lshrrev_b32 v8, 1, v8
  v_xor_b32 v8, s32, v8
  v_lshl_add_u32 v9, v8, 6, v9
  v_bfe_u32 v8, v1, 4, 1
  v_lshl_add_u32 v9, v8, 5, v9
  v_and_b32 v8, 3, v1
  v_lshl_add_u32 v20, v8, 3, v9
  s_mov_b32 s28, 0xffff0000
  s_mov_b32 s29, 0xbfb8aa3b
  s_waitcnt vmcnt(2)
  v_lshlrev_b32 v96, 16, v32
  v_and_b32 v97, s28, v32
  v_lshlrev_b32 v98, 16, v40
  v_and_b32 v99, s28, v40
  v_lshlrev_b32 v100, 16, v48
  v_and_b32 v101, s28, v48
  v_lshlrev_b32 v102, 16, v56
  v_and_b32 v103, s28, v56
  v_pk_add_f32 v[96:97], v[96:97], v[98:99]
  v_pk_add_f32 v[100:101], v[100:101], v[102:103]
  v_pk_add_f32 v[96:97], v[96:97], v[100:101]
  v_cvt_pk_bf16_f32 v98, v96, v97
  v_lshlrev_b32 v96, 16, v98
  v_and_b32 v97, s28, v98
  v_mul_f32 v98, s29, v96
  v_mul_f32 v99, s29, v97
  v_exp_f32 v98, v98
  v_exp_f32 v99, v99
  s_nop 0
  v_pk_add_f32 v[98:99], v[98:99], 1.0 op_sel_hi:[1,0]
  v_rcp_f32 v98, v98
  v_rcp_f32 v99, v99
  s_nop 0
  v_pk_mul_f32 v[96:97], v[96:97], v[98:99]
  v_cvt_pk_bf16_f32 v98, v96, v97
  v_lshlrev_b32 v80, 16, v98
  v_and_b32 v81, s28, v98
  v_lshlrev_b32 v96, 16, v33
  v_and_b32 v97, s28, v33
  v_lshlrev_b32 v98, 16, v41
  v_and_b32 v99, s28, v41
  v_lshlrev_b32 v100, 16, v49
  v_and_b32 v101, s28, v49
  v_lshlrev_b32 v102, 16, v57
  v_and_b32 v103, s28, v57
  v_pk_add_f32 v[96:97], v[96:97], v[98:99]
  v_pk_add_f32 v[100:101], v[100:101], v[102:103]
  v_pk_add_f32 v[96:97], v[96:97], v[100:101]
  v_cvt_pk_bf16_f32 v98, v96, v97
  v_lshlrev_b32 v96, 16, v98
  v_and_b32 v97, s28, v98
  v_mul_f32 v98, s29, v96
  v_mul_f32 v99, s29, v97
  v_exp_f32 v98, v98
  v_exp_f32 v99, v99
  s_nop 0
  v_pk_add_f32 v[98:99], v[98:99], 1.0 op_sel_hi:[1,0]
  v_rcp_f32 v98, v98
  v_rcp_f32 v99, v99
  s_nop 0
  v_pk_mul_f32 v[96:97], v[96:97], v[98:99]
  v_cvt_pk_bf16_f32 v98, v96, v97
  v_lshlrev_b32 v82, 16, v98
  v_and_b32 v83, s28, v98
  v_lshlrev_b32 v96, 16, v34
  v_and_b32 v97, s28, v34
  v_lshlrev_b32 v98, 16, v42
  v_and_b32 v99, s28, v42
  v_lshlrev_b32 v100, 16, v50
  v_and_b32 v101, s28, v50
  v_lshlrev_b32 v102, 16, v58
  v_and_b32 v103, s28, v58
  v_pk_add_f32 v[96:97], v[96:97], v[98:99]
  v_pk_add_f32 v[100:101], v[100:101], v[102:103]
  v_pk_add_f32 v[96:97], v[96:97], v[100:101]
  v_cvt_pk_bf16_f32 v98, v96, v97
  v_lshlrev_b32 v96, 16, v98
  v_and_b32 v97, s28, v98
  v_mul_f32 v98, s29, v96
  v_mul_f32 v99, s29, v97
  v_exp_f32 v98, v98
  v_exp_f32 v99, v99
  s_nop 0
  v_pk_add_f32 v[98:99], v[98:99], 1.0 op_sel_hi:[1,0]
  v_rcp_f32 v98, v98
  v_rcp_f32 v99, v99
  s_nop 0
  v_pk_mul_f32 v[96:97], v[96:97], v[98:99]
  v_cvt_pk_bf16_f32 v98, v96, v97
  v_lshlrev_b32 v84, 16, v98
  v_and_b32 v85, s28, v98
  v_lshlrev_b32 v96, 16, v35
  v_and_b32 v97, s28, v35
  v_lshlrev_b32 v98, 16, v43
  v_and_b32 v99, s28, v43
  v_lshlrev_b32 v100, 16, v51
  v_and_b32 v101, s28, v51
  v_lshlrev_b32 v102, 16, v59
  v_and_b32 v103, s28, v59
  v_pk_add_f32 v[96:97], v[96:97], v[98:99]
  v_pk_add_f32 v[100:101], v[100:101], v[102:103]
  v_pk_add_f32 v[96:97], v[96:97], v[100:101]
  v_cvt_pk_bf16_f32 v98, v96, v97
  v_lshlrev_b32 v96, 16, v98
  v_and_b32 v97, s28, v98
  v_mul_f32 v98, s29, v96
  v_mul_f32 v99, s29, v97
  v_exp_f32 v98, v98
  v_exp_f32 v99, v99
  s_nop 0
  v_pk_add_f32 v[98:99], v[98:99], 1.0 op_sel_hi:[1,0]
  v_rcp_f32 v98, v98
  v_rcp_f32 v99, v99
  s_nop 0
  v_pk_mul_f32 v[96:97], v[96:97], v[98:99]
  v_cvt_pk_bf16_f32 v98, v96, v97
  v_lshlrev_b32 v86, 16, v98
  v_and_b32 v87, s28, v98
  v_lshlrev_b32 v96, 16, v36
  v_and_b32 v97, s28, v36
  v_lshlrev_b32 v98, 16, v44
  v_and_b32 v99, s28, v44
  v_lshlrev_b32 v100, 16, v52
  v_and_b32 v101, s28, v52
  v_lshlrev_b32 v102, 16, v60
  v_and_b32 v103, s28, v60
  v_pk_add_f32 v[96:97], v[96:97], v[98:99]
  v_pk_add_f32 v[100:101], v[100:101], v[102:103]
  v_pk_add_f32 v[96:97], v[96:97], v[100:101]
  v_cvt_pk_bf16_f32 v98, v96, v97
  v_lshlrev_b32 v96, 16, v98
  v_and_b32 v97, s28, v98
  v_mul_f32 v98, s29, v96
  v_mul_f32 v99, s29, v97
  v_exp_f32 v98, v98
  v_exp_f32 v99, v99
  s_nop 0
  v_pk_add_f32 v[98:99], v[98:99], 1.0 op_sel_hi:[1,0]
  v_rcp_f32 v98, v98
  v_rcp_f32 v99, v99
  s_nop 0
  v_pk_mul_f32 v[96:97], v[96:97], v[98:99]
  v_cvt_pk_bf16_f32 v98, v96, v97
  v_lshlrev_b32 v88, 16, v98
  v_and_b32 v89, s28, v98
  v_lshlrev_b32 v96, 16, v37
  v_and_b32 v97, s28, v37
  v_lshlrev_b32 v98, 16, v45
  v_and_b32 v99, s28, v45
  v_lshlrev_b32 v100, 16, v53
  v_and_b32 v101, s28, v53
  v_lshlrev_b32 v102, 16, v61
  v_and_b32 v103, s28, v61
  v_pk_add_f32 v[96:97], v[96:97], v[98:99]
  v_pk_add_f32 v[100:101], v[100:101], v[102:103]
  v_pk_add_f32 v[96:97], v[96:97], v[100:101]
  v_cvt_pk_bf16_f32 v98, v96, v97
  v_lshlrev_b32 v96, 16, v98
  v_and_b32 v97, s28, v98
  v_mul_f32 v98, s29, v96
  v_mul_f32 v99, s29, v97
  v_exp_f32 v98, v98
  v_exp_f32 v99, v99
  s_nop 0
  v_pk_add_f32 v[98:99], v[98:99], 1.0 op_sel_hi:[1,0]
  v_rcp_f32 v98, v98
  v_rcp_f32 v99, v99
  s_nop 0
  v_pk_mul_f32 v[96:97], v[96:97], v[98:99]
  v_cvt_pk_bf16_f32 v98, v96, v97
  v_lshlrev_b32 v90, 16, v98
  v_and_b32 v91, s28, v98
  v_lshlrev_b32 v96, 16, v38
  v_and_b32 v97, s28, v38
  v_lshlrev_b32 v98, 16, v46
  v_and_b32 v99, s28, v46
  v_lshlrev_b32 v100, 16, v54
  v_and_b32 v101, s28, v54
  v_lshlrev_b32 v102, 16, v62
  v_and_b32 v103, s28, v62
  v_pk_add_f32 v[96:97], v[96:97], v[98:99]
  v_pk_add_f32 v[100:101], v[100:101], v[102:103]
  v_pk_add_f32 v[96:97], v[96:97], v[100:101]
  v_cvt_pk_bf16_f32 v98, v96, v97
  v_lshlrev_b32 v96, 16, v98
  v_and_b32 v97, s28, v98
  v_mul_f32 v98, s29, v96
  v_mul_f32 v99, s29, v97
  v_exp_f32 v98, v98
  v_exp_f32 v99, v99
  s_nop 0
  v_pk_add_f32 v[98:99], v[98:99], 1.0 op_sel_hi:[1,0]
  v_rcp_f32 v98, v98
  v_rcp_f32 v99, v99
  s_nop 0
  v_pk_mul_f32 v[96:97], v[96:97], v[98:99]
  v_cvt_pk_bf16_f32 v98, v96, v97
  v_lshlrev_b32 v92, 16, v98
  v_and_b32 v93, s28, v98
  v_lshlrev_b32 v96, 16, v39
  v_and_b32 v97, s28, v39
  v_lshlrev_b32 v98, 16, v47
  v_and_b32 v99, s28, v47
  v_lshlrev_b32 v100, 16, v55
  v_and_b32 v101, s28, v55
  v_lshlrev_b32 v102, 16, v63
  v_and_b32 v103, s28, v63
  v_pk_add_f32 v[96:97], v[96:97], v[98:99]
  v_pk_add_f32 v[100:101], v[100:101], v[102:103]
  v_pk_add_f32 v[96:97], v[96:97], v[100:101]
  v_cvt_pk_bf16_f32 v98, v96, v97
  v_lshlrev_b32 v96, 16, v98
  v_and_b32 v97, s28, v98
  v_mul_f32 v98, s29, v96
  v_mul_f32 v99, s29, v97
  v_exp_f32 v98, v98
  v_exp_f32 v99, v99
  s_nop 0
  v_pk_add_f32 v[98:99], v[98:99], 1.0 op_sel_hi:[1,0]
  v_rcp_f32 v98, v98
  v_rcp_f32 v99, v99
  s_nop 0
  v_pk_mul_f32 v[96:97], v[96:97], v[98:99]
  v_cvt_pk_bf16_f32 v98, v96, v97
  v_lshlrev_b32 v94, 16, v98
  v_and_b32 v95, s28, v98
  s_waitcnt vmcnt(0)
  v_lshlrev_b32 v96, 16, v64
  v_and_b32 v97, s28, v64
  v_lshlrev_b32 v98, 16, v65
  v_and_b32 v99, s28, v65
  v_lshlrev_b32 v100, 16, v66
  v_and_b32 v101, s28, v66
  v_lshlrev_b32 v102, 16, v67
  v_and_b32 v103, s28, v67
  v_lshlrev_b32 v104, 16, v68
  v_and_b32 v105, s28, v68
  v_lshlrev_b32 v106, 16, v69
  v_and_b32 v107, s28, v69
  v_lshlrev_b32 v108, 16, v70
  v_and_b32 v109, s28, v70
  v_lshlrev_b32 v110, 16, v71
  v_and_b32 v111, s28, v71
  s_barrier
  ds_read_b128 v[32:35], v16 offset:0
  ds_read_b64_tr_b16 v[36:37], v20 offset:0
  ds_read_b64_tr_b16 v[38:39], v20 offset:512
  ds_read_b128 v[40:43], v17 offset:0
  ds_read_b64_tr_b16 v[44:45], v20 offset:2048
  ds_read_b64_tr_b16 v[46:47], v20 offset:2560
  ds_read_b128 v[48:51], v18 offset:0
  ds_read_b64_tr_b16 v[52:53], v20 offset:4096
  ds_read_b64_tr_b16 v[54:55], v20 offset:4608
  s_waitcnt lgkmcnt(6)
  v_mfma_f32_32x32x16_bf16 v[112:127], v[32:35], v[36:39], 0
  ds_read_b128 v[32:35], v19 offset:0
  ds_read_b64_tr_b16 v[36:37], v20 offset:6144
  ds_read_b64_tr_b16 v[38:39], v20 offset:6656
  s_waitcnt lgkmcnt(6)
  v_mfma_f32_32x32x16_bf16 v[112:127], v[40:43], v[44:47], v[112:127]
  s_barrier
  ds_read_b128 v[40:43], v16 offset:8192
  ds_read_b64_tr_b16 v[44:45], v20 offset:8192
  ds_read_b64_tr_b16 v[46:47], v20 offset:8704
  s_waitcnt lgkmcnt(6)
  v_mfma_f32_32x32x16_bf16 v[112:127], v[48:51], v[52:55], v[112:127]
  ds_read_b128 v[48:51], v17 offset:8192
  ds_read_b64_tr_b16 v[52:53], v20 offset:10240
  ds_read_b64_tr_b16 v[54:55], v20 offset:10752
  s_waitcnt lgkmcnt(6)
  v_mfma_f32_32x32x16_bf16 v[112:127], v[32:35], v[36:39], v[112:127]
  ds_read_b128 v[32:35], v18 offset:8192
  ds_read_b64_tr_b16 v[36:37], v20 offset:12288
  ds_read_b64_tr_b16 v[38:39], v20 offset:12800
  s_waitcnt lgkmcnt(6)
  v_mfma_f32_32x32x16_bf16 v[112:127], v[40:43], v[44:47], v[112:127]
  ds_read_b128 v[40:43], v19 offset:8192
  ds_read_b64_tr_b16 v[44:45], v20 offset:14336
  ds_read_b64_tr_b16 v[46:47], v20 offset:14848
  s_waitcnt lgkmcnt(6)
  v_mfma_f32_32x32x16_bf16 v[112:127], v[48:51], v[52:55], v[112:127]
  s_barrier
  ds_read_b128 v[48:51], v16 offset:16384
  ds_read_b64_tr_b16 v[52:53], v20 offset:16384
  ds_read_b64_tr_b16 v[54:55], v20 offset:16896
  s_waitcnt lgkmcnt(6)
  v_mfma_f32_32x32x16_bf16 v[112:127], v[32:35], v[36:39], v[112:127]
  ds_read_b128 v[32:35], v17 offset:16384
  ds_read_b64_tr_b16 v[36:37], v20 offset:18432
  ds_read_b64_tr_b16 v[38:39], v20 offset:18944
  s_waitcnt lgkmcnt(6)
  v_mfma_f32_32x32x16_bf16 v[112:127], v[40:43], v[44:47], v[112:127]
  ds_read_b128 v[40:43], v18 offset:16384
  ds_read_b64_tr_b16 v[44:45], v20 offset:20480
  ds_read_b64_tr_b16 v[46:47], v20 offset:20992
  s_waitcnt lgkmcnt(6)
  v_mfma_f32_32x32x16_bf16 v[112:127], v[48:51], v[52:55], v[112:127]
  ds_read_b128 v[48:51], v19 offset:16384
  ds_read_b64_tr_b16 v[52:53], v20 offset:22528
  ds_read_b64_tr_b16 v[54:55], v20 offset:23040
  s_waitcnt lgkmcnt(6)
  v_mfma_f32_32x32x16_bf16 v[112:127], v[32:35], v[36:39], v[112:127]
  s_barrier
  ds_read_b128 v[32:35], v16 offset:24576
  ds_read_b64_tr_b16 v[36:37], v20 offset:24576
  ds_read_b64_tr_b16 v[38:39], v20 offset:25088
  s_waitcnt lgkmcnt(6)
  v_mfma_f32_32x32x16_bf16 v[112:127], v[40:43], v[44:47], v[112:127]
  ds_read_b128 v[40:43], v17 offset:24576
  ds_read_b64_tr_b16 v[44:45], v20 offset:26624
  ds_read_b64_tr_b16 v[46:47], v20 offset:27136
  s_waitcnt lgkmcnt(6)
  v_mfma_f32_32x32x16_bf16 v[112:127], v[48:51], v[52:55], v[112:127]
  ds_read_b128 v[48:51], v18 offset:24576
  ds_read_b64_tr_b16 v[52:53], v20 offset:28672
  ds_read_b64_tr_b16 v[54:55], v20 offset:29184
  s_waitcnt lgkmcnt(6)
  v_mfma_f32_32x32x16_bf16 v[112:127], v[32:35], v[36:39], v[112:127]
  ds_read_b128 v[32:35], v19 offset:24576
  ds_read_b64_tr_b16 v[36:37], v20 offset:30720
  ds_read_b64_tr_b16 v[38:39], v20 offset:31232
  s_waitcnt lgkmcnt(6)
  v_mfma_f32_32x32x16_bf16 v[112:127], v[40:43], v[44:47], v[112:127]
  s_barrier
  ds_read_b128 v[40:43], v16 offset:32768
  ds_read_b64_tr_b16 v[44:45], v20 offset:32768
  ds_read_b64_tr_b16 v[46:47], v20 offset:33280
  s_waitcnt lgkmcnt(6)
  v_mfma_f32_32x32x16_bf16 v[112:127], v[48:51], v[52:55], v[112:127]
  ds_read_b128 v[48:51], v17 offset:32768
  ds_read_b64_tr_b16 v[52:53], v20 offset:34816
  ds_read_b64_tr_b16 v[54:55], v20 offset:35328
  s_waitcnt lgkmcnt(6)
  v_mfma_f32_32x32x16_bf16 v[112:127], v[32:35], v[36:39], v[112:127]
  ds_read_b128 v[32:35], v18 offset:32768
  ds_read_b64_tr_b16 v[36:37], v20 offset:36864
  ds_read_b64_tr_b16 v[38:39], v20 offset:37376
  s_waitcnt lgkmcnt(6)
  v_mfma_f32_32x32x16_bf16 v[112:127], v[40:43], v[44:47], v[112:127]
  ds_read_b128 v[40:43], v19 offset:32768
  ds_read_b64_tr_b16 v[44:45], v20 offset:38912
  ds_read_b64_tr_b16 v[46:47], v20 offset:39424
  s_waitcnt lgkmcnt(6)
  v_mfma_f32_32x32x16_bf16 v[112:127], v[48:51], v[52:55], v[112:127]
  s_barrier
  ds_read_b128 v[48:51], v16 offset:40960
  ds_read_b64_tr_b16 v[52:53], v20 offset:40960
  ds_read_b64_tr_b16 v[54:55], v20 offset:41472
  s_waitcnt lgkmcnt(6)
  v_mfma_f32_32x32x16_bf16 v[112:127], v[32:35], v[36:39], v[112:127]
  ds_read_b128 v[32:35], v17 offset:40960
  ds_read_b64_tr_b16 v[36:37], v20 offset:43008
  ds_read_b64_tr_b16 v[38:39], v20 offset:43520
  s_waitcnt lgkmcnt(6)
  v_mfma_f32_32x32x16_bf16 v[112:127], v[40:43], v[44:47], v[112:127]
  ds_read_b128 v[40:43], v18 offset:40960
  ds_read_b64_tr_b16 v[44:45], v20 offset:45056
  ds_read_b64_tr_b16 v[46:47], v20 offset:45568
  s_waitcnt lgkmcnt(6)
  v_mfma_f32_32x32x16_bf16 v[112:127], v[48:51], v[52:55], v[112:127]
  ds_read_b128 v[48:51], v19 offset:40960
  ds_read_b64_tr_b16 v[52:53], v20 offset:47104
  ds_read_b64_tr_b16 v[54:55], v20 offset:47616
  s_waitcnt lgkmcnt(6)
  v_mfma_f32_32x32x16_bf16 v[112:127], v[32:35], v[36:39], v[112:127]
  s_barrier
  ds_read_b128 v[32:35], v16 offset:49152
  ds_read_b64_tr_b16 v[36:37], v20 offset:49152
  ds_read_b64_tr_b16 v[38:39], v20 offset:49664
  s_waitcnt lgkmcnt(6)
  v_mfma_f32_32x32x16_bf16 v[112:127], v[40:43], v[44:47], v[112:127]
  ds_read_b128 v[40:43], v17 offset:49152
  ds_read_b64_tr_b16 v[44:45], v20 offset:51200
  ds_read_b64_tr_b16 v[46:47], v20 offset:51712
  s_waitcnt lgkmcnt(6)
  v_mfma_f32_32x32x16_bf16 v[112:127], v[48:51], v[52:55], v[112:127]
  ds_read_b128 v[48:51], v18 offset:49152
  ds_read_b64_tr_b16 v[52:53], v20 offset:53248
  ds_read_b64_tr_b16 v[54:55], v20 offset:53760
  s_waitcnt lgkmcnt(6)
  v_mfma_f32_32x32x16_bf16 v[112:127], v[32:35], v[36:39], v[112:127]
  ds_read_b128 v[32:35], v19 offset:49152
  ds_read_b64_tr_b16 v[36:37], v20 offset:55296
  ds_read_b64_tr_b16 v[38:39], v20 offset:55808
  s_waitcnt lgkmcnt(6)
  v_mfma_f32_32x32x16_bf16 v[112:127], v[40:43], v[44:47], v[112:127]
  s_waitcnt lgkmcnt(3)
  v_mfma_f32_32x32x16_bf16 v[112:127], v[48:51], v[52:55], v[112:127]
  s_waitcnt lgkmcnt(0)
  v_mfma_f32_32x32x16_bf16 v[112:127], v[32:35], v[36:39], v[112:127]
  s_nop 7
  s_nop 7
  v_cvt_pk_bf16_f32 v32, v112, v113
  v_cvt_pk_bf16_f32 v33, v114, v115
  v_cvt_pk_bf16_f32 v34, v116, v117
  v_cvt_pk_bf16_f32 v35, v118, v119
  v_cvt_pk_bf16_f32 v36, v120, v121
  v_cvt_pk_bf16_f32 v37, v122, v123
  v_cvt_pk_bf16_f32 v38, v124, v125
  v_cvt_pk_bf16_f32 v39, v126, v127
  v_lshlrev_b32 v112, 16, v32
  v_and_b32 v113, s28, v32
  v_lshlrev_b32 v114, 16, v33
  v_and_b32 v115, s28, v33
  v_lshlrev_b32 v116, 16, v34
  v_and_b32 v117, s28, v34
  v_lshlrev_b32 v118, 16, v35
  v_and_b32 v119, s28, v35
  v_lshlrev_b32 v120, 16, v36
  v_and_b32 v121, s28, v36
  v_lshlrev_b32 v122, 16, v37
  v_and_b32 v123, s28, v37
  v_lshlrev_b32 v124, 16, v38
  v_and_b32 v125, s28, v38
  v_lshlrev_b32 v126, 16, v39
  v_and_b32 v127, s28, v39
  v_pk_mul_f32 v[112:113], v[112:113], v[80:81]
  v_pk_mul_f32 v[114:115], v[114:115], v[82:83]
  v_pk_mul_f32 v[116:117], v[116:117], v[84:85]
  v_pk_mul_f32 v[118:119], v[118:119], v[86:87]
  v_pk_mul_f32 v[120:121], v[120:121], v[88:89]
  v_pk_mul_f32 v[122:123], v[122:123], v[90:91]
  v_pk_mul_f32 v[124:125], v[124:125], v[92:93]
  v_pk_mul_f32 v[126:127], v[126:127], v[94:95]
  v_cvt_pk_bf16_f32 v32, v112, v113
  v_cvt_pk_bf16_f32 v33, v114, v115
  v_cvt_pk_bf16_f32 v34, v116, v117
  v_cvt_pk_bf16_f32 v35, v118, v119
  v_cvt_pk_bf16_f32 v36, v120, v121
  v_cvt_pk_bf16_f32 v37, v122, v123
  v_cvt_pk_bf16_f32 v38, v124, v125
  v_cvt_pk_bf16_f32 v39, v126, v127
  v_lshlrev_b32 v112, 16, v32
  v_and_b32 v113, s28, v32
  v_lshlrev_b32 v114, 16, v33
  v_and_b32 v115, s28, v33
  v_lshlrev_b32 v116, 16, v34
  v_and_b32 v117, s28, v34
  v_lshlrev_b32 v118, 16, v35
  v_and_b32 v119, s28, v35
  v_lshlrev_b32 v120, 16, v36
  v_and_b32 v121, s28, v36
  v_lshlrev_b32 v122, 16, v37
  v_and_b32 v123, s28, v37
  v_lshlrev_b32 v124, 16, v38
  v_and_b32 v125, s28, v38
  v_lshlrev_b32 v126, 16, v39
  v_and_b32 v127, s28, v39
  v_pk_add_f32 v[112:113], v[112:113], v[96:97]
  v_pk_add_f32 v[114:115], v[114:115], v[98:99]
  v_pk_add_f32 v[116:117], v[116:117], v[100:101]
  v_pk_add_f32 v[118:119], v[118:119], v[102:103]
  v_pk_add_f32 v[120:121], v[120:121], v[104:105]
  v_pk_add_f32 v[122:123], v[122:123], v[106:107]
  v_pk_add_f32 v[124:125], v[124:125], v[108:109]
  v_pk_add_f32 v[126:127], v[126:127], v[110:111]
  v_cvt_pk_bf16_f32 v32, v112, v113
  v_cvt_pk_bf16_f32 v33, v114, v115
  v_cvt_pk_bf16_f32 v34, v116, v117
  v_cvt_pk_bf16_f32 v35, v118, v119
  v_cvt_pk_bf16_f32 v36, v120, v121
  v_cvt_pk_bf16_f32 v37, v122, v123
  v_cvt_pk_bf16_f32 v38, v124, v125
  v_cvt_pk_bf16_f32 v39, v126, v127
  ds_write_b128 v21, v[32:35]
  ds_write_b128 v21, v[36:39] offset:32
  s_waitcnt lgkmcnt(0)
  s_barrier
  ds_read_b128 v[32:35], v22
  ds_read_b128 v[36:39], v22 offset:1152
  s_waitcnt lgkmcnt(1)
  buffer_store_dwordx4 v[32:35], v23, s[20:23], s36 offen sc1
  s_waitcnt lgkmcnt(0)
  buffer_store_dwordx4 v[36:39], v23, s[20:23], s37 offen sc1
Lfin3:
Lend3:
  s_endpgm
.set T0, 0x3f80
.set T1, 0x3f80
.set T2, 0x3f80
.set T3, 0x3f80
.set T4, 0x3f80
.set T5, 0x3f7f
.set T6, 0x3f7f
.set T7, 0x3f7f
.set T8, 0x3f7e
.set T9, 0x3f7e
.set T10, 0x3f7d
.set T11, 0x3f7d
.set T12, 0x3f7c
.set T13, 0x3f7c
.set T14, 0x3f7b
.set T15, 0x3f7a
.set T16, 0x3f7a
.set T17, 0x3f79
.set T18, 0x3f78
.set T19, 0x3f77
.set T20, 0x3f76
.set T21, 0x3f75
.set T22, 0x3f74
.set T23, 0x3f73
.set T24, 0x3f72
.set T25, 0x3f70
.set T26, 0x3f6f
.set T27, 0x3f6e
.set T28, 0x3f6d
.set T29, 0x3f6b
.set T30, 0x3f6a
.set T31, 0x3f68
.set T32, 0x3f67
.set T33, 0x3f65
.set T34, 0x3f63
.set T35, 0x3f62
.set T36, 0x3f60
.set T37, 0x3f5e
.set T38, 0x3f5c
.set T39, 0x3f5b
.set T40, 0x3f59
.set T41, 0x3f57
.set T42, 0x3f55
.set T43, 0x3f53
.set T44, 0x3f51
.set T45, 0x3f4f
.set T46, 0x3f4d
.set T47, 0x3f4a
.set T48, 0x3f48
.set T49, 0x3f46
.set T50, 0x3f44
.set T51, 0x3f41
.set T52, 0x3f3f
.set T53, 0x3f3c
.set T54, 0x3f3a
.set T55, 0x3f38
.set T56, 0x3f35
.set T57, 0x3f32
.set T58, 0x3f30
.set T59, 0x3f2d
.set T60, 0x3f2b
.set T61, 0x3f28
.set T62, 0x3f25
.set T63, 0x3f22
.set T64, 0x3f20
.set T65, 0x3f1d
.set T66, 0x3f1a
.set T67, 0x3f17
.set T68, 0x3f14
.set T69, 0x3f11
.set T70, 0x3f0e
.set T71, 0x3f0b
.set T72, 0x3f08
.set T73, 0x3f05
.set T74, 0x3f02
.set T75, 0x3efe
.set T76, 0x3ef8
.set T77, 0x3ef1
.set T78, 0x3eeb
.set T79, 0x3ee5
.set T80, 0x3ede
.set T81, 0x3ed8
.set T82, 0x3ed1
.set T83, 0x3ecb
.set T84, 0x3ec4
.set T85, 0x3ebd
.set T86, 0x3eb7
.set T87, 0x3eb0
.set T88, 0x3ea9
.set T89, 0x3ea2
.set T90, 0x3e9b
.set T91, 0x3e95
.set T92, 0x3e8e
.set T93, 0x3e87
.set T94, 0x3e80
.set T95, 0x3e72
.set T96, 0x3e64
.set T97, 0x3e56
.set T98, 0x3e48
.set T99, 0x3e3a
.set T100, 0x3e2c
.set T101, 0x3e1d
.set T102, 0x3e0f
.set T103, 0x3e01
.set T104, 0x3de5
.set T105, 0x3dc9
.set T106, 0x3dac
.set T107, 0x3d8f
.set T108, 0x3d66
.set T109, 0x3d2c
.set T110, 0x3ce6
.set T111, 0x3c66
.set T112, 0x248d
.set T113, 0xbc66
.set T114, 0xbce6
.set T115, 0xbd2c
.set T116, 0xbd66
.set T117, 0xbd8f
.set T118, 0xbdac
.set T119, 0xbdc9
.set T120, 0xbde5
.set T121, 0xbe01
.set T122, 0xbe0f
.set T123, 0xbe1d
.set T124, 0xbe2c
.set T125, 0xbe3a
.set T126, 0xbe48
.set T127, 0xbe56
.set T128, 0xbe64
.set T129, 0xbe72
.set T130, 0xbe80
.set T131, 0xbe87
.set T132, 0xbe8e
.set T133, 0xbe95
.set T134, 0xbe9b
.set T135, 0xbea2
.set T136, 0xbea9
.set T137, 0xbeb0
.set T138, 0xbeb7
.set T139, 0xbebd
.set T140, 0xbec4
.set T141, 0xbecb
.set T142, 0xbed1
.set T143, 0xbed8
.set T144, 0xbede
.set T145, 0xbee5
.set T146, 0xbeeb
.set T147, 0xbef1
.set T148, 0xbef8
.set T149, 0xbefe
.set T150, 0xbf02
.set T151, 0xbf05
.set T152, 0xbf08
.set T153, 0xbf0b
.set T154, 0xbf0e
.set T155, 0xbf11
.set T156, 0xbf14
.set T157, 0xbf17
.set T158, 0xbf1a
.set T159, 0xbf1d
.set T160, 0xbf20
.set T161, 0xbf22
.set T162, 0xbf25
.set T163, 0xbf28
.set T164, 0xbf2b
.set T165, 0xbf2d
.set T166, 0xbf30
.set T167, 0xbf32
.set T168, 0xbf35
.set T169, 0xbf38
.set T170, 0xbf3a
.set T171, 0xbf3c
.set T172, 0xbf3f
.set T173, 0xbf41
.set T174, 0xbf44
.set T175, 0xbf46
.set T176, 0xbf48
.set T177, 0xbf4a
.set T178, 0xbf4d
.set T179, 0xbf4f
.set T180, 0xbf51
.set T181, 0xbf53
.set T182, 0xbf55
.set T183, 0xbf57
.set T184, 0xbf59
.set T185, 0xbf5b
.set T186, 0xbf5c
.set T187, 0xbf5e
.set T188, 0xbf60
.set T189, 0xbf62
.set T190, 0xbf63
.set T191, 0xbf65
.set T192, 0xbf67
.set T193, 0xbf68
.set T194, 0xbf6a
.set T195, 0xbf6b
.set T196, 0xbf6d
.set T197, 0xbf6e
.set T198, 0xbf6f
.set T199, 0xbf70
.set T200, 0xbf72
.set T201, 0xbf73
.set T202, 0xbf74
.set T203, 0xbf75
.set T204, 0xbf76
.set T205, 0xbf77
.set T206, 0xbf78
.set T207, 0xbf79
.set T208, 0xbf7a
.set T209, 0xbf7a
.set T210, 0xbf7b
.set T211, 0xbf7c
.set T212, 0xbf7c
.set T213, 0xbf7d
.set T214, 0xbf7d
.set T215, 0xbf7e
.set T216, 0xbf7e
.set T217, 0xbf7f
.set T218, 0xbf7f
.set T219, 0xbf7f
.set T220, 0xbf80
.set T221, 0xbf80
.set T222, 0xbf80
.set T223, 0xbf80
.set T224, 0xbf80
.set T225, 0xbf80
.set T226, 0xbf80
.set T227, 0xbf80
.set T228, 0xbf80
.set T229, 0xbf7f
.set T230, 0xbf7f
.set T231, 0xbf7f
.set T232, 0xbf7e
.set T233, 0xbf7e
.set T234, 0xbf7d
.set T235, 0xbf7d
.set T236, 0xbf7c
.set T237, 0xbf7c
.set T238, 0xbf7b
.set T239, 0xbf7a
.set T240, 0xbf7a
.set T241, 0xbf79
.set T242, 0xbf78
.set T243, 0xbf77
.set T244, 0xbf76
.set T245, 0xbf75
.set T246, 0xbf74
.set T247, 0xbf73
.set T248, 0xbf72
.set T249, 0xbf70
.set T250, 0xbf6f
.set T251, 0xbf6e
.set T252, 0xbf6d
.set T253, 0xbf6b
.set T254, 0xbf6a
.set T255, 0xbf68
.set T256, 0xbf67
.set T257, 0xbf65
.set T258, 0xbf63
.set T259, 0xbf62
.set T260, 0xbf60
.set T261, 0xbf5e
.set T262, 0xbf5c
.set T263, 0xbf5b
.set T264, 0xbf59
.set T265, 0xbf57
.set T266, 0xbf55
.set T267, 0xbf53
.set T268, 0xbf51
.set T269, 0xbf4f
.set T270, 0xbf4d
.set T271, 0xbf4a
.set T272, 0xbf48
.set T273, 0xbf46
.set T274, 0xbf44
.set T275, 0xbf41
.set T276, 0xbf3f
.set T277, 0xbf3c
.set T278, 0xbf3a
.set T279, 0xbf38
.set T280, 0xbf35
.set T281, 0xbf32
.set T282, 0xbf30
.set T283, 0xbf2d
.set T284, 0xbf2b
.set T285, 0xbf28
.set T286, 0xbf25
.set T287, 0xbf22
.set T288, 0xbf20
.set T289, 0xbf1d
.set T290, 0xbf1a
.set T291, 0xbf17
.set T292, 0xbf14
.set T293, 0xbf11
.set T294, 0xbf0e
.set T295, 0xbf0b
.set T296, 0xbf08
.set T297, 0xbf05
.set T298, 0xbf02
.set T299, 0xbefe
.set T300, 0xbef8
.set T301, 0xbef1
.set T302, 0xbeeb
.set T303, 0xbee5
.set T304, 0xbede
.set T305, 0xbed8
.set T306, 0xbed1
.set T307, 0xbecb
.set T308, 0xbec4
.set T309, 0xbebd
.set T310, 0xbeb7
.set T311, 0xbeb0
.set T312, 0xbea9
.set T313, 0xbea2
.set T314, 0xbe9b
.set T315, 0xbe95
.set T316, 0xbe8e
.set T317, 0xbe87
.set T318, 0xbe80
.set T319, 0xbe72
.set T320, 0xbe64
.set T321, 0xbe56
.set T322, 0xbe48
.set T323, 0xbe3a
.set T324, 0xbe2c
.set T325, 0xbe1d
.set T326, 0xbe0f
.set T327, 0xbe01
.set T328, 0xbde5
.set T329, 0xbdc9
.set T330, 0xbdac
.set T331, 0xbd8f
.set T332, 0xbd66
.set T333, 0xbd2c
.set T334, 0xbce6
.set T335, 0xbc66
.set T336, 0xa554
.set T337, 0x3c66
.set T338, 0x3ce6
.set T339, 0x3d2c
.set T340, 0x3d66
.set T341, 0x3d8f
.set T342, 0x3dac
.set T343, 0x3dc9
.set T344, 0x3de5
.set T345, 0x3e01
.set T346, 0x3e0f
.set T347, 0x3e1d
.set T348, 0x3e2c
.set T349, 0x3e3a
.set T350, 0x3e48
.set T351, 0x3e56
.set T352, 0x3e64
.set T353, 0x3e72
.set T354, 0x3e80
.set T355, 0x3e87
.set T356, 0x3e8e
.set T357, 0x3e95
.set T358, 0x3e9b
.set T359, 0x3ea2
.set T360, 0x3ea9
.set T361, 0x3eb0
.set T362, 0x3eb7
.set T363, 0x3ebd
.set T364, 0x3ec4
.set T365, 0x3ecb
.set T366, 0x3ed1
.set T367, 0x3ed8
.set T368, 0x3ede
.set T369, 0x3ee5
.set T370, 0x3eeb
.set T371, 0x3ef1
.set T372, 0x3ef8
.set T373, 0x3efe
.set T374, 0x3f02
.set T375, 0x3f05
.set T376, 0x3f08
.set T377, 0x3f0b
.set T378, 0x3f0e
.set T379, 0x3f11
.set T380, 0x3f14
.set T381, 0x3f17
.set T382, 0x3f1a
.set T383, 0x3f1d
.set T384, 0x3f20
.set T385, 0x3f22
.set T386, 0x3f25
.set T387, 0x3f28
.set T388, 0x3f2b
.set T389, 0x3f2d
.set T390, 0x3f30
.set T391, 0x3f32
.set T392, 0x3f35
.set T393, 0x3f38
.set T394, 0x3f3a
.set T395, 0x3f3c
.set T396, 0x3f3f
.set T397, 0x3f41
.set T398, 0x3f44
.set T399, 0x3f46
.set T400, 0x3f48
.set T401, 0x3f4a
.set T402, 0x3f4d
.set T403, 0x3f4f
.set T404, 0x3f51
.set T405, 0x3f53
.set T406, 0x3f55
.set T407, 0x3f57
.set T408, 0x3f59
.set T409, 0x3f5b
.set T410, 0x3f5c
.set T411, 0x3f5e
.set T412, 0x3f60
.set T413, 0x3f62
.set T414, 0x3f63
.set T415, 0x3f65
.set T416, 0x3f67
.set T417, 0x3f68
.set T418, 0x3f6a
.set T419, 0x3f6b
.set T420, 0x3f6d
.set T421, 0x3f6e
.set T422, 0x3f6f
.set T423, 0x3f70
.set T424, 0x3f72
.set T425, 0x3f73
.set T426, 0x3f74
.set T427, 0x3f75
.set T428, 0x3f76
.set T429, 0x3f77
.set T430, 0x3f78
.set T431, 0x3f79
.set T432, 0x3f7a
.set T433, 0x3f7a
.set T434, 0x3f7b
.set T435, 0x3f7c
.set T436, 0x3f7c
.set T437, 0x3f7d
.set T438, 0x3f7d
.set T439, 0x3f7e
.set T440, 0x3f7e
.set T441, 0x3f7f
.set T442, 0x3f7f
.set T443, 0x3f7f
.set T444, 0x3f80
.set T445, 0x3f80
.set T446, 0x3f80
.set T447, 0x3f80

.altmacro
.macro E2 a, b
.long T\a | (T\b << 16)
.endm
.p2align 8
.type ftab,@object
ftab:
.set tn, 0
.rept 448
E2 0, %((tn*224) % 448)
.set tf, 1
.rept 223
E2 %((tn*tf) % 448), %((tn*tf+112) % 448)
.set tf, tf+1
.endr
.set tn, tn+1
.endr
.size ftab, 401408
.noaltmacro
.section .rodata,"a"
.p2align 6
.amdhsa_kernel k1_kernel
  .amdhsa_next_free_vgpr 160
  .amdhsa_next_free_sgpr 96
  .amdhsa_accum_offset 160
  .amdhsa_group_segment_fixed_size 0
  .amdhsa_kernarg_size 72
  .amdhsa_user_sgpr_count 2
  .amdhsa_user_sgpr_kernarg_segment_ptr 1
  .amdhsa_system_sgpr_workgroup_id_x 1
.end_amdhsa_kernel
.p2align 6
.amdhsa_kernel k2_kernel
  .amdhsa_next_free_vgpr 168
  .amdhsa_next_free_sgpr 96
  .amdhsa_accum_offset 168
  .amdhsa_group_segment_fixed_size 0
  .amdhsa_kernarg_size 72
  .amdhsa_user_sgpr_count 2
  .amdhsa_user_sgpr_kernarg_segment_ptr 1
  .amdhsa_system_sgpr_workgroup_id_x 1
.end_amdhsa_kernel
.p2align 6
.amdhsa_kernel k3_kernel
  .amdhsa_next_free_vgpr 128
  .amdhsa_next_free_sgpr 96
  .amdhsa_accum_offset 128
  .amdhsa_group_segment_fixed_size 0
  .amdhsa_kernarg_size 72
  .amdhsa_user_sgpr_count 2
  .amdhsa_user_sgpr_kernarg_segment_ptr 1
  .amdhsa_system_sgpr_workgroup_id_x 1
.end_amdhsa_kernel
```
